```python
import torch

def _softmax(x, axis=-1):
    return torch.softmax(x, dim=axis)
def _gelu(x):
    return torch.nn.functional.gelu(x, approximate="tanh")
def _silu(x):
    return torch.nn.functional.silu(x)
def _sigmoid(x):
    return torch.sigmoid(x)
def _layernorm(x, axis=-1, eps=1e-5):
    m = x.mean(dim=axis, keepdim=True)
    v = x.var(dim=axis, keepdim=True, unbiased=False)
    return (x - m) / torch.sqrt(v + eps)
def _scatter_add(tgt, idx, src, axis=0):
    return tgt.clone().index_add_(axis, idx, src)
def _segment_sum(src, seg, n):
    out = torch.zeros((n,) + src.shape[1:], dtype=src.dtype)
    return out.index_add_(0, seg, src)
def _pad(x, pw):
    flat = tuple(v for pair in reversed(pw) for v in pair)
    return torch.nn.functional.pad(x, flat)

kernel_name = 'recurrent_scan__gqa_block_cached__glu_gated_reglu__decode'

def setup_inputs():

    _w = (lambda a: (lambda t: t.to(torch.bfloat16) if t.is_floating_point() else t)(torch.as_tensor(a)))
    def _A_setup():
        B, Sq, D = 2, 1, 576
        Hq, Hkv, Sk, Dh = 32, 16, 32768, 128
        assert Hq % Hkv == 0, (Hq, Hkv)
        return {
            "x": _w((lambda *s: torch.randn(*s, dtype=torch.bfloat16) * 0.4)(B, Sq, D)),
            "k_cache": _w((lambda *s: torch.randn(*s, dtype=torch.bfloat16) * 1.6)(B, Hkv, Sk, Dh)),
            "v_cache": _w((lambda *s: torch.randn(*s, dtype=torch.bfloat16) * 1.6)(B, Hkv, Sk, Dh)),
            "wq": _w((lambda *s: torch.randn(*s, dtype=torch.bfloat16) * 1.6)(D, Hq * Dh) * (D ** -0.5)),
            "wo": _w((lambda *s: torch.randn(*s, dtype=torch.bfloat16) * 1.6)(Hq * Dh, D) * ((Hq * Dh) ** -0.5)),
        }
    _A_in = _A_setup()

    def _B_setup():
        B, S, D, F = 2, 1, 576, 4608
        return {
            "x": _w((lambda *s: torch.randn(*s, dtype=torch.bfloat16) * 0.4)(B, S, D)),
            "W_gate": _w((lambda *s: torch.randn(*s, dtype=torch.bfloat16) * 1.6)(D, F) * (2.0 / D) ** 0.5),
            "W_up": _w((lambda *s: torch.randn(*s, dtype=torch.bfloat16) * 1.6)(D, F) * (2.0 / D) ** 0.5),
            "W_down": _w((lambda *s: torch.randn(*s, dtype=torch.bfloat16) * 1.6)(F, D) * (1.0 / F) ** 0.5),
        }
    _B_in = _B_setup()

    return {
        "A_x": _A_in["x"],
        "A_k_cache": _A_in["k_cache"],
        "A_v_cache": _A_in["v_cache"],
        "A_wq": _A_in["wq"],
        "A_wo": _A_in["wo"],
        "B_x": _B_in["x"],
        "B_W_gate": _B_in["W_gate"],
        "B_W_up": _B_in["W_up"],
        "B_W_down": _B_in["W_down"],
    }

def reference(A_x, A_k_cache, A_v_cache, A_wq, A_wo, B_x, B_W_gate, B_W_up, B_W_down):
    def _A_ref(x, k_cache, v_cache, wq, wo):
        B, Sq, D = x.shape
        Hq, Dh = 32, 128
        Hkv = k_cache.shape[1]
        rep = Hq // Hkv
        q = (lambda x, *d: x.permute(*d))((x @ wq).reshape(B, Sq, Hq, Dh), 0, 2, 1, 3)
        k = (lambda x, n, axis: torch.repeat_interleave(x, n, dim=axis))(k_cache, rep, axis=1)
        v = (lambda x, n, axis: torch.repeat_interleave(x, n, dim=axis))(v_cache, rep, axis=1)
        scores = torch.einsum("bhqd,bhkd->bhqk", q, k) * (Dh ** -0.5)
        p = _softmax(scores, axis=-1)
        o = torch.einsum("bhqk,bhkd->bhqd", p, v)
        return (lambda x, *d: x.permute(*d))(o, 0, 2, 1, 3).reshape(B, Sq, Hq * Dh) @ wo

    def _B_ref(x, W_gate, W_up, W_down):
        gate = torch.einsum("bsd,df->bsf", x, W_gate)
        up = torch.einsum("bsd,df->bsf", x, W_up)
        gate = gate * (lambda x, dt: x.to(dt))(gate > 0, gate.dtype)
        h = gate * up
        return torch.einsum("bsf,fd->bsd", h, W_down)

    x = A_x
    xn = _layernorm(x, axis=-1)
    s = _A_ref(xn, A_k_cache, A_v_cache, A_wq, A_wo)
    g = _silu(_B_ref(xn, B_W_gate, B_W_up, B_W_down))
    return x + s * g
```

```asm
; @launch grid=(256,1,1) block=(320,1,1) lds=152384
.amdgcn_target "amdgcn-amd-amdhsa--gfx950"
.text
.globl recurrent_scan__gqa_block_cached__glu_gated_reglu__decode_kernel
.p2align 8
.type recurrent_scan__gqa_block_cached__glu_gated_reglu__decode_kernel,@function
recurrent_scan__gqa_block_cached__glu_gated_reglu__decode_kernel:
s_cmp_ge_u32 s2, 256
s_cbranch_scc1 L_end
s_load_dwordx16 s[4:19], s[0:1], 0
s_load_dwordx8 s[20:27], s[0:1], 64
s_getpc_b64 s[52:53]
L_pc:
v_lshlrev_b32 v1, 6, v0
v_min_u32 v1, L_end-L_pc, v1
global_load_dword v167, v1, s[52:53]
v_lshrrev_b32 v1, 6, v0
v_and_b32 v0, 63, v0
v_readfirstlane_b32 s3, v1
s_and_b32 s28, s2, 7
s_lshr_b32 s29, s2, 3
s_and_b32 s51, s2, 3
s_lshl3_add_u32 s51, s51, s28
s_xor_b32 s29, s29, s51
s_lshr_b32 s30, s29, 4
s_and_b32 s31, s29, 15
s_lshl3_add_u32 s32, s30, s28
s_add_u32 s69, s28, s29
s_and_b32 s69, s69, 7
s_lshr_b32 s33, s29, 3
s_lshl2_add_u32 s33, s33, s69
s_sub_u32 s33, s33, 2
s_and_b32 s71, s33, 1
s_lshl1_add_u32 s71, s28, s71
s_lshr_b32 s33, s33, 1
s_mul_i32 s61, s29, 3
s_add_u32 s61, s61, s69
s_sub_u32 s61, s61, 24
s_cmp_lt_u32 s29, 8
s_cselect_b32 s64, 2, 4
s_cselect_b32 s65, 0, 3
s_cmp_lt_u32 s69, s64
s_cselect_b32 s33, 15, s33
s_cmp_lt_u32 s69, s65
s_cselect_b32 s61, s61, 72
v_lshrrev_b32 v1, 4, v0
v_and_b32 v2, 15, v0
s_cmp_eq_u32 s3, 4
s_cbranch_scc1 L_aux
v_xor_b32 v3, v2, v1
v_lshlrev_b32 v3, 4, v3
v_lshl_or_b32 v4, v1, 8, v3
v_xor_b32 v5, 64, v4
v_xor_b32 v6, 128, v4
v_xor_b32 v7, 192, v4
v_lshlrev_b32 v22, 1, v1
v_xor_b32 v22, v22, v2
v_lshlrev_b32 v22, 4, v22
v_lshl_or_b32 v8, v1, 8, v22
v_xor_b32 v9, 0x80, v8
v_and_b32 v22, 1, v1
v_lshrrev_b32 v23, 1, v1
v_mul_u32_u24 v22, 0x300, v22
v_mul_u32_u24 v23, 0x600, v23
v_add_u32 v22, v22, v23
s_mov_b32 s51, 0x0
v_add3_u32 v136, s51, v22, v4
v_add3_u32 v140, s51, v22, v8
s_mov_b32 s51, 0xc00
v_add3_u32 v137, s51, v22, v5
v_add3_u32 v141, s51, v22, v9
s_mov_b32 s51, 0x1ff800
v_add3_u32 v138, s51, v22, v6
v_add3_u32 v142, s51, v22, v8
s_mov_b32 s51, 0x200400
v_add3_u32 v139, s51, v22, v7
v_add3_u32 v143, s51, v22, v9
s_lshl_b32 s47, s3, 14
s_mov_b32 s39, 0x20000
s_mov_b32 s43, 0x20000
s_cmp_eq_u32 s3, 3
s_cbranch_scc1 L_ffn
s_lshl3_add_u32 s69, s3, s28
s_lshl_b32 s67, s69, 1
s_bfe_u32 s44, s67, 0x20000
s_lshl_b32 s44, s44, 8
s_bfe_u32 s52, s67, 0x80002
s_lshl_b32 s52, s52, 13
s_or_b32 s44, s44, s52
s_add_u32 s66, s44, 0x100
s_lshl_b32 s51, s29, 23
s_mov_b32 s38, 0x800000
s_mov_b32 s42, 0x800000
s_mov_b32 s45, 0
s_mov_b32 m0, s47
s_waitcnt lgkmcnt(0)
s_add_u32 s36, s6, s51
s_addc_u32 s37, s7, 0
s_add_u32 s40, s8, s51
s_addc_u32 s41, s9, 0
s_load_dword s70, s[26:27], 0x44000
s_barrier
s_mov_b32 s60, 0x400000
v_mov_b32 v76, 0x25300
L_kw:
ds_read_b32 v77, v76
s_sub_u32 s60, s60, 1
s_cbranch_scc1 L_kw_out
s_waitcnt lgkmcnt(0)
v_cmp_gt_u32 vcc, 2, v77
s_cbranch_vccnz L_kw
L_kw_out:
L_fill:
buffer_load_dwordx4 v136, s[36:39], s44 offen offset:0 nt lds
buffer_load_dwordx4 v137, s[36:39], s44 offen offset:1024 nt lds
buffer_load_dwordx4 v138, s[36:39], s44 offen offset:2048 nt lds
buffer_load_dwordx4 v139, s[36:39], s44 offen offset:3072 nt lds
s_add_u32 m0, m0, 4096
s_nop 0
buffer_load_dwordx4 v136, s[36:39], s66 offen offset:0 nt lds
buffer_load_dwordx4 v137, s[36:39], s66 offen offset:1024 nt lds
buffer_load_dwordx4 v138, s[36:39], s66 offen offset:2048 nt lds
buffer_load_dwordx4 v139, s[36:39], s66 offen offset:3072 nt lds
s_add_u32 s45, s45, 1
s_add_u32 s67, s67, 48
s_bfe_u32 s44, s67, 0x20000
s_lshl_b32 s44, s44, 8
s_bfe_u32 s52, s67, 0x80002
s_lshl_b32 s52, s52, 13
s_or_b32 s44, s44, s52
s_bfe_u32 s52, s67, 0x1000a
s_lshl_b32 s52, s52, 22
s_or_b32 s44, s44, s52
s_add_u32 s66, s44, 0x100
s_bitcmp1_b32 s45, 0
s_cselect_b32 s51, 0, 0x10000
s_bitset1_b32 s51, 13
s_xor_b32 s47, s47, s51
s_mov_b32 m0, s47
s_cmp_eq_u32 s45, 4
s_cbranch_scc1 L_fill_end
s_waitcnt vmcnt(0)
s_branch L_fill
L_fill_end:
s_waitcnt lgkmcnt(0)
s_and_b32 s51, s70, 0x80808080
s_and_b32 s70, s70, 0x7f7f7f7f
s_add_u32 s70, s70, 0x04030201
s_xor_b32 s70, s70, s51
s_bfe_u32 s76, s70, 0x80000
s_bfe_u32 s77, s70, 0x80008
s_bfe_u32 s78, s70, 0x80010
s_bfe_u32 s79, s70, 0x80018
L_filled:
v_lshl_or_b32 v10, v2, 8, v3
v_add_u32 v10, s47, v10
v_xor_b32 v11, 64, v10
v_xor_b32 v12, 128, v10
v_xor_b32 v13, 192, v10
v_lshrrev_b32 v22, 2, v0
v_and_b32 v23, 7, v22
v_lshlrev_b32 v23, 5, v23
v_lshl_or_b32 v23, v22, 8, v23
v_and_b32 v22, 3, v0
v_lshl_or_b32 v23, v22, 3, v23
v_add_u32 v14, s47, v23
v_xor_b32 v15, 32, v14
v_xor_b32 v16, 64, v14
v_xor_b32 v17, 96, v14
v_xor_b32 v18, 128, v14
v_xor_b32 v19, 160, v14
v_xor_b32 v20, 192, v14
v_xor_b32 v21, 224, v14
v_mov_b64 v[84:85], 0
v_mov_b64 v[86:87], 0
v_mov_b64 v[88:89], 0
v_mov_b64 v[90:91], 0
v_mov_b64 v[92:93], 0
v_mov_b64 v[94:95], 0
v_mov_b64 v[96:97], 0
v_mov_b64 v[98:99], 0
v_mov_b64 v[100:101], 0
v_mov_b64 v[102:103], 0
v_mov_b64 v[104:105], 0
v_mov_b64 v[106:107], 0
v_mov_b64 v[108:109], 0
v_mov_b64 v[110:111], 0
v_mov_b64 v[112:113], 0
v_mov_b64 v[114:115], 0
v_mov_b32 v116, 0xff800000
v_mov_b32 v117, 0xff800000
v_mov_b32 v118, 0
v_mov_b32 v121, 1
s_mul_i32 s51, s29, 256
s_add_u32 s51, s51, 0xf0000
v_mov_b32 v120, s51
v_and_b32 v22, 1, v0
v_lshlrev_b32 v22, 8, v22
v_lshl_or_b32 v22, v1, 4, v22
v_add_u32 v22, 0x25100, v22
s_lshr_b32 s58, s3, 1
s_lshl1_add_u32 s59, s71, s58
s_lshl_b32 s51, s59, 12
s_add_u32 s51, s51, 0x20000
s_add_u32 s72, s26, s51
s_addc_u32 s73, s27, 0
s_mov_b32 s74, 4096
s_mov_b32 s75, 0x20000
s_lshl_b32 s51, s71, 7
s_add_u32 s51, s51, s58
s_lshl4_add_u32 s51, s51, 0x48000
v_lshl_add_u32 v129, v2, 7, s51
v_lshrrev_b32 v124, 2, v2
v_lshl_or_b32 v124, v1, 3, v124
v_lshlrev_b32 v124, 7, v124
v_and_b32 v23, 3, v0
v_lshl_or_b32 v124, v23, 3, v124
v_lshrrev_b32 v23, 3, v2
v_lshl_or_b32 v124, v23, 5, v124
s_lshl_b32 s51, s58, 15
s_add_u32 s51, s51, 0x10000
s_and_b32 s58, s3, 1
s_lshl_b32 s52, s58, 6
v_xor_b32 v124, s52, v124
v_add_u32 v124, s51, v124
v_xor_b32 v125, 0x240, v124
v_xor_b32 v126, 0x20, v124
v_xor_b32 v127, 0x260, v124
s_mul_i32 s51, s59, 4608
s_lshl1_add_u32 s52, s33, s58
s_lshl_b32 s52, s52, 8
s_add_u32 s51, s51, s52
s_add_u32 s51, s51, 0x50000
v_lshlrev_b32 v23, 6, v1
v_lshl_or_b32 v23, v2, 4, v23
v_add_u32 v130, s51, v23
v_mov_b32 v132, 0xffffff00
v_lshrrev_b32 v23, 3, v0
v_and_b32 v131, 6, v23
v_xor_b32 v131, v0, v131
v_and_b32 v131, 7, v131
v_mul_u32_u24 v23, 1152, v23
v_lshl_add_u32 v131, v131, 4, v23
s_mov_b32 s62, 0xcccccccc
s_mov_b32 s63, 0xcccccccc
s_add_u32 s53, s28, s29
s_and_b32 s53, s53, 7
s_cmp_lt_u32 s29, 8
s_cselect_b32 s51, 6, 7
s_cselect_b32 s52, 224, 0
s_sub_u32 s52, s52, 56
s_mul_i32 s15, s29, s51
s_add_u32 s15, s15, s52
s_add_u32 s15, s15, s53
s_cmp_lt_u32 s53, s51
s_cselect_b32 s14, 1, 0
s_cselect_b32 s15, s15, 0
s_mul_i32 s51, s15, 171
s_lshr_b32 s51, s51, 9
s_mul_i32 s52, s51, 3
s_sub_u32 s52, s15, s52
s_mul_i32 s52, s52, 3
s_add_u32 s52, s52, s3
s_lshl_b32 s52, s52, 7
s_mul_i32 s15, s51, 4608
s_lshl2_add_u32 s15, s52, s15
s_add_u32 s15, s15, 0x80000
s_mul_i32 s51, s51, 73728
s_add_u32 s51, s51, s52
s_add_u32 s16, s20, s51
s_addc_u32 s17, s21, 0
s_sub_u32 s18, 73728, s52
s_mov_b32 s19, 0x20000
s_cmp_eq_u32 s3, 3
s_cselect_b32 s14, 0, s14
s_cbranch_scc1 L_w3done
s_mov_b32 s46, 0xfffffff2
s_mov_b32 s48, 0x140000
s_mov_b32 s49, 0
s_mov_b32 s65, 0
s_mov_b32 s54, 0x3db504f3
s_mov_b32 s55, 0x3fb8aa3b
s_mov_b32 s56, 0xffff0000
s_mul_i32 s51, s3, 6144
s_add_u32 s51, s51, 0x20000
v_and_b32 v153, 1, v0
v_lshl_or_b32 v153, v1, 1, v153
v_lshl_add_u32 v153, v153, 4, s51
v_mov_b32 v152, 0xff800000
s_lshl_b32 s52, s29, 16
s_add_u32 s52, s52, 0x140000
v_and_b32 v164, 3, v0
v_lshl_or_b32 v164, v1, 2, v164
v_lshl_add_u32 v164, v164, 4, s52
v_mov_b32 v162, v164
v_mov_b32 v163, v162
s_mov_b32 s34, 0
s_mov_b32 s35, 0
s_mov_b32 s68, 0
s_mov_b32 s57, 0
s_mov_b32 s60, 0x400000
v_mov_b32 v76, 0x25300
L_qwait:
ds_read_b32 v77, v76
s_sub_u32 s60, s60, 1
s_cbranch_scc1 L_qwait_out
s_waitcnt lgkmcnt(0)
v_cmp_gt_u32 vcc, 3, v77
s_cbranch_vccnz L_qwait
L_qwait_out:
ds_read_b128 v[24:27], v22 offset:0
ds_read_b128 v[28:31], v22 offset:64
ds_read_b128 v[32:35], v22 offset:128
ds_read_b128 v[36:39], v22 offset:192
s_waitcnt vmcnt(24)
s_branch L_kc
L_kph:
s_bitcmp1_b32 s46, 0
s_cbranch_scc0 L_kc
s_mov_b32 m0, s47
s_cmp_ge_u32 s45, 39
s_cbranch_scc1 L_kdyn
s_waitcnt vmcnt(0)
L_kiss:
buffer_load_dwordx4 v136, s[36:39], s44 offen offset:0 nt lds
buffer_load_dwordx4 v137, s[36:39], s44 offen offset:1024 nt lds
buffer_load_dwordx4 v138, s[36:39], s44 offen offset:2048 nt lds
buffer_load_dwordx4 v139, s[36:39], s44 offen offset:3072 nt lds
s_add_u32 m0, m0, 4096
s_xor_b32 s47, s47, 0x2000
buffer_load_dwordx4 v136, s[36:39], s66 offen offset:0 nt lds
buffer_load_dwordx4 v137, s[36:39], s66 offen offset:1024 nt lds
buffer_load_dwordx4 v138, s[36:39], s66 offen offset:2048 nt lds
buffer_load_dwordx4 v139, s[36:39], s66 offen offset:3072 nt lds
L_kadv:
s_add_u32 s45, s45, 1
s_add_u32 s67, s67, 48
s_bfe_u32 s44, s67, 0x20000
s_lshl_b32 s44, s44, 8
s_bfe_u32 s52, s67, 0x80002
s_lshl_b32 s52, s52, 13
s_or_b32 s44, s44, s52
s_bfe_u32 s52, s67, 0x1000a
s_lshl_b32 s52, s52, 22
s_or_b32 s44, s44, s52
s_add_u32 s66, s44, 0x100
L_kc:
ds_read_b128 v[40:43], v10 offset:0
ds_read_b128 v[44:47], v11 offset:0
ds_read_b128 v[48:51], v12 offset:0
ds_read_b128 v[52:55], v13 offset:0
ds_read_b128 v[56:59], v10 offset:4096
ds_read_b128 v[60:63], v11 offset:4096
ds_read_b128 v[64:67], v12 offset:4096
ds_read_b128 v[68:71], v13 offset:4096
s_ashr_i32 s46, s46, 1
s_lshr_b32 s48, s48, 1
s_and_b32 s50, s48, 0x10000
s_bitset1_b32 s50, 13
s_waitcnt lgkmcnt(7)
v_mfma_f32_16x16x32_bf16 v[72:75], v[40:43], v[24:27], 0
s_waitcnt lgkmcnt(6)
v_mfma_f32_16x16x32_bf16 v[72:75], v[44:47], v[28:31], v[72:75]
s_waitcnt lgkmcnt(5)
v_mfma_f32_16x16x32_bf16 v[72:75], v[48:51], v[32:35], v[72:75]
s_waitcnt lgkmcnt(4)
v_mfma_f32_16x16x32_bf16 v[72:75], v[52:55], v[36:39], v[72:75]
s_waitcnt lgkmcnt(3)
v_mfma_f32_16x16x32_bf16 v[144:147], v[56:59], v[24:27], 0
s_waitcnt lgkmcnt(2)
v_mfma_f32_16x16x32_bf16 v[144:147], v[60:63], v[28:31], v[144:147]
s_waitcnt lgkmcnt(1)
v_mfma_f32_16x16x32_bf16 v[144:147], v[64:67], v[32:35], v[144:147]
s_waitcnt lgkmcnt(0)
v_mfma_f32_16x16x32_bf16 v[144:147], v[68:71], v[36:39], v[144:147]
v_xor_b32 v10, s50, v10
v_xor_b32 v11, s50, v11
v_xor_b32 v12, s50, v12
v_xor_b32 v13, s50, v13
v_xor_b32 v14, s50, v14
v_xor_b32 v15, s50, v15
v_xor_b32 v16, s50, v16
v_xor_b32 v17, s50, v17
v_xor_b32 v18, s50, v18
v_xor_b32 v19, s50, v19
v_xor_b32 v20, s50, v20
v_xor_b32 v21, s50, v21
v_cvt_pk_bf16_f32 v76, v72, v73
v_cvt_pk_bf16_f32 v77, v74, v75
v_lshlrev_b32 v72, 16, v76
v_and_b32 v73, s56, v76
v_lshlrev_b32 v74, 16, v77
v_and_b32 v75, s56, v77
v_mul_f32 v72, s54, v72
v_mul_f32 v73, s54, v73
v_mul_f32 v74, s54, v74
v_mul_f32 v75, s54, v75
v_cvt_pk_bf16_f32 v76, v144, v145
v_cvt_pk_bf16_f32 v77, v146, v147
v_lshlrev_b32 v144, 16, v76
v_and_b32 v145, s56, v76
v_lshlrev_b32 v146, 16, v77
v_and_b32 v147, s56, v77
v_mul_f32 v144, s54, v144
v_mul_f32 v145, s54, v145
v_mul_f32 v146, s54, v146
v_mul_f32 v147, s54, v147
s_cmp_lg_u32 s34, 0
s_cbranch_scc1 L_ksink
v_cvt_pk_bf16_f32 v148, v72, v73
v_cvt_pk_bf16_f32 v149, v74, v75
v_max3_f32 v152, v152, v72, v73
v_max3_f32 v152, v152, v74, v75
v_cvt_pk_bf16_f32 v150, v144, v145
v_cvt_pk_bf16_f32 v151, v146, v147
v_max3_f32 v152, v152, v144, v145
v_max3_f32 v152, v152, v146, v147
s_mov_b32 exec_lo, 0x00030003
s_mov_b32 exec_hi, 0x00030003
ds_write_b128 v153, v[148:151]
s_mov_b64 exec, -1
v_add_u32 v153, 128, v153
L_knext:
s_mov_b32 s34, s35
s_cmp_eq_u32 s65, 0
s_cbranch_scc1 L_kph
s_cmp_eq_u32 s68, 0
s_cbranch_scc1 L_kf0
s_mov_b32 exec_lo, 0x000f000f
s_mov_b32 exec_hi, 0x000f000f
global_store_dwordx4 v163, v[154:157], s[26:27] sc1
s_mov_b64 exec, -1
s_mov_b32 s68, 0
L_kf0:
v_cvt_pk_bf16_f32 v76, v152, v152
v_subrev_u32 v153, 5120, v153
v_lshlrev_b32 v76, 16, v76
s_branch L_newmax2
L_ksink:
v_cndmask_b32 v154, v72, v144, s[62:63]
v_cndmask_b32 v155, v73, v145, s[62:63]
v_cndmask_b32 v156, v74, v146, s[62:63]
v_cndmask_b32 v157, v75, v147, s[62:63]
v_cvt_pk_bf16_f32 v76, v154, v155
v_cvt_pk_bf16_f32 v77, v156, v157
v_lshlrev_b32 v154, 16, v76
v_and_b32 v155, s56, v76
v_lshlrev_b32 v156, 16, v77
v_and_b32 v157, s56, v77
v_and_or_b32 v154, v154, v132, s76
v_and_or_b32 v155, v155, v132, s77
v_and_or_b32 v156, v156, v132, s78
v_and_or_b32 v157, v157, v132, s79
v_add_u32 v163, s64, v164
s_mov_b32 s68, 1
s_branch L_knext
L_kdyn:
s_cmp_eq_u32 s45, 39
s_cbranch_scc1 L_kcl
s_mov_b32 s64, s57
s_waitcnt vmcnt(8)
v_readfirstlane_b32 s51, v119
s_add_u32 s51, s51, 1
s_cmp_ge_u32 s51, 64
s_cbranch_scc1 L_kend
s_lshl_b32 s57, s51, 8
s_lshl1_add_u32 s67, s51, 1920
s_bfe_u32 s44, s67, 0x20000
s_lshl_b32 s44, s44, 8
s_bfe_u32 s52, s67, 0x80002
s_lshl_b32 s52, s52, 13
s_or_b32 s44, s44, s52
s_bfe_u32 s52, s67, 0x1000a
s_lshl_b32 s52, s52, 22
s_or_b32 s44, s44, s52
s_add_u32 s66, s44, 0x100
s_mov_b32 s35, 1
L_kcl:
s_waitcnt vmcnt(0)
s_cmp_eq_u32 s68, 0
s_cbranch_scc1 L_kf1
s_mov_b32 exec_lo, 0x000f000f
s_mov_b32 exec_hi, 0x000f000f
global_store_dwordx4 v163, v[154:157], s[26:27] sc1
s_mov_b64 exec, -1
s_mov_b32 s68, 0
L_kf1:
s_mov_b64 exec, 1
global_atomic_add v119, v120, v121, s[26:27] offset:0 sc0 sc1
s_mov_b64 exec, -1
s_branch L_kiss
L_kend:
s_lshl_b32 s67, s69, 1
s_bfe_u32 s44, s67, 0x20000
s_lshl_b32 s44, s44, 8
s_bfe_u32 s52, s67, 0x80002
s_lshl_b32 s52, s52, 13
s_or_b32 s44, s44, s52
s_bfe_u32 s52, s67, 0x1000a
s_lshl_b32 s52, s52, 22
s_or_b32 s44, s44, s52
s_add_u32 s66, s44, 0x100
s_waitcnt vmcnt(0)
s_cmp_eq_u32 s68, 0
s_cbranch_scc1 L_kf2
s_mov_b32 exec_lo, 0x000f000f
s_mov_b32 exec_hi, 0x000f000f
global_store_dwordx4 v163, v[154:157], s[26:27] sc1
s_mov_b64 exec, -1
s_mov_b32 s68, 0
L_kf2:
buffer_load_dwordx4 v140, s[40:43], s44 offen offset:0 nt lds
buffer_load_dwordx4 v141, s[40:43], s44 offen offset:1024 nt lds
buffer_load_dwordx4 v142, s[40:43], s44 offen offset:2048 nt lds
buffer_load_dwordx4 v143, s[40:43], s44 offen offset:3072 nt lds
s_add_u32 m0, m0, 4096
s_xor_b32 s47, s47, 0x2000
buffer_load_dwordx4 v140, s[40:43], s66 offen offset:0 nt lds
buffer_load_dwordx4 v141, s[40:43], s66 offen offset:1024 nt lds
buffer_load_dwordx4 v142, s[40:43], s66 offen offset:2048 nt lds
buffer_load_dwordx4 v143, s[40:43], s66 offen offset:3072 nt lds
s_mov_b32 s45, 0
s_mov_b32 s35, 0
s_mov_b32 s65, 1
s_branch L_kadv
L_exp2:
s_mov_b32 m0, s47
s_cmp_ge_u32 s45, 39
s_cbranch_scc1 L_vend
s_waitcnt vmcnt(0)
L_viss:
buffer_load_dwordx4 v140, s[40:43], s44 offen offset:0 nt lds
buffer_load_dwordx4 v141, s[40:43], s44 offen offset:1024 nt lds
buffer_load_dwordx4 v142, s[40:43], s44 offen offset:2048 nt lds
buffer_load_dwordx4 v143, s[40:43], s44 offen offset:3072 nt lds
s_add_u32 m0, m0, 4096
s_xor_b32 s47, s47, 0x2000
buffer_load_dwordx4 v140, s[40:43], s66 offen offset:0 nt lds
buffer_load_dwordx4 v141, s[40:43], s66 offen offset:1024 nt lds
buffer_load_dwordx4 v142, s[40:43], s66 offen offset:2048 nt lds
buffer_load_dwordx4 v143, s[40:43], s66 offen offset:3072 nt lds
s_add_u32 s45, s45, 1
s_add_u32 s67, s67, 48
s_bfe_u32 s44, s67, 0x20000
s_lshl_b32 s44, s44, 8
s_bfe_u32 s52, s67, 0x80002
s_lshl_b32 s52, s52, 13
s_or_b32 s44, s44, s52
s_bfe_u32 s52, s67, 0x1000a
s_lshl_b32 s52, s52, 22
s_or_b32 s44, s44, s52
s_add_u32 s66, s44, 0x100
L_vs:
ds_read_b128 v[148:151], v153
v_add_u32 v153, 128, v153
s_waitcnt lgkmcnt(0)
v_lshlrev_b32 v72, 16, v148
v_and_b32 v73, s56, v148
v_lshlrev_b32 v74, 16, v149
v_and_b32 v75, s56, v149
v_lshlrev_b32 v144, 16, v150
v_and_b32 v145, s56, v150
v_lshlrev_b32 v146, 16, v151
v_and_b32 v147, s56, v151
L_exp:
ds_read_b64_tr_b16 v[40:41], v14 offset:0
ds_read_b64_tr_b16 v[42:43], v14 offset:4096
ds_read_b64_tr_b16 v[44:45], v15 offset:0
ds_read_b64_tr_b16 v[46:47], v15 offset:4096
ds_read_b64_tr_b16 v[48:49], v16 offset:0
ds_read_b64_tr_b16 v[50:51], v16 offset:4096
ds_read_b64_tr_b16 v[52:53], v17 offset:0
ds_read_b64_tr_b16 v[54:55], v17 offset:4096
ds_read_b64_tr_b16 v[56:57], v18 offset:0
ds_read_b64_tr_b16 v[58:59], v18 offset:4096
ds_read_b64_tr_b16 v[60:61], v19 offset:0
ds_read_b64_tr_b16 v[62:63], v19 offset:4096
ds_read_b64_tr_b16 v[64:65], v20 offset:0
ds_read_b64_tr_b16 v[66:67], v20 offset:4096
v_fma_f32 v72, v72, s55, -v117
v_fma_f32 v73, v73, s55, -v117
v_fma_f32 v74, v74, s55, -v117
v_fma_f32 v75, v75, s55, -v117
v_fma_f32 v144, v144, s55, -v117
v_fma_f32 v145, v145, s55, -v117
v_fma_f32 v146, v146, s55, -v117
v_fma_f32 v147, v147, s55, -v117
v_exp_f32 v72, v72
v_exp_f32 v73, v73
v_exp_f32 v74, v74
v_exp_f32 v75, v75
v_exp_f32 v144, v144
v_exp_f32 v145, v145
v_exp_f32 v146, v146
v_exp_f32 v147, v147
ds_read_b64_tr_b16 v[68:69], v21 offset:0
s_waitcnt lgkmcnt(14)
ds_read_b64_tr_b16 v[70:71], v21 offset:4096
v_cvt_pk_bf16_f32 v148, v72, v73
v_cvt_pk_bf16_f32 v149, v74, v75
v_cvt_pk_bf16_f32 v150, v144, v145
v_cvt_pk_bf16_f32 v151, v146, v147
v_pk_add_f32 v[72:73], v[72:73], v[74:75]
v_pk_add_f32 v[144:145], v[144:145], v[146:147]
s_cmp_eq_u32 s34, 0
s_waitcnt lgkmcnt(14)
v_mfma_f32_16x16x32_bf16 v[84:87], v[40:43], v[148:151], v[84:87]
v_pk_add_f32 v[72:73], v[72:73], v[144:145]
s_waitcnt lgkmcnt(12)
v_mfma_f32_16x16x32_bf16 v[88:91], v[44:47], v[148:151], v[88:91]
v_add_f32 v72, v72, v73
s_waitcnt lgkmcnt(10)
v_mfma_f32_16x16x32_bf16 v[92:95], v[48:51], v[148:151], v[92:95]
v_add_f32 v118, v118, v72
s_waitcnt lgkmcnt(8)
v_mfma_f32_16x16x32_bf16 v[96:99], v[52:55], v[148:151], v[96:99]
s_waitcnt lgkmcnt(6)
v_mfma_f32_16x16x32_bf16 v[100:103], v[56:59], v[148:151], v[100:103]
s_waitcnt lgkmcnt(4)
v_mfma_f32_16x16x32_bf16 v[104:107], v[60:63], v[148:151], v[104:107]
s_waitcnt lgkmcnt(2)
v_mfma_f32_16x16x32_bf16 v[108:111], v[64:67], v[148:151], v[108:111]
s_waitcnt lgkmcnt(0)
v_mfma_f32_16x16x32_bf16 v[112:115], v[68:71], v[148:151], v[112:115]
v_xor_b32 v14, 0x2000, v14
v_xor_b32 v15, 0x2000, v15
v_xor_b32 v16, 0x2000, v16
v_xor_b32 v17, 0x2000, v17
v_xor_b32 v18, 0x2000, v18
v_xor_b32 v19, 0x2000, v19
v_xor_b32 v20, 0x2000, v20
v_xor_b32 v21, 0x2000, v21
s_cbranch_scc1 L_exp2
s_cmp_lg_u32 s49, 0
s_cbranch_scc1 L_done
s_mov_b32 m0, s47
s_waitcnt vmcnt(9)
L_vdyn:
v_readfirstlane_b32 s51, v119
s_add_u32 s51, s51, 1
s_cmp_ge_u32 s51, 64
s_cbranch_scc1 L_last
s_lshl_b32 s57, s51, 8
s_lshl1_add_u32 s67, s51, 1920
s_bfe_u32 s44, s67, 0x20000
s_lshl_b32 s44, s44, 8
s_bfe_u32 s52, s67, 0x80002
s_lshl_b32 s52, s52, 13
s_or_b32 s44, s44, s52
s_bfe_u32 s52, s67, 0x1000a
s_lshl_b32 s52, s52, 22
s_or_b32 s44, s44, s52
s_add_u32 s66, s44, 0x100
s_waitcnt vmcnt(0)
s_mov_b64 exec, 1
global_atomic_add v119, v120, v121, s[26:27] offset:128 sc0 sc1
s_mov_b64 exec, -1
buffer_load_dwordx4 v140, s[40:43], s44 offen offset:0 nt lds
buffer_load_dwordx4 v141, s[40:43], s44 offen offset:1024 nt lds
buffer_load_dwordx4 v142, s[40:43], s44 offen offset:2048 nt lds
buffer_load_dwordx4 v143, s[40:43], s44 offen offset:3072 nt lds
s_add_u32 m0, m0, 4096
s_xor_b32 s47, s47, 0x2000
buffer_load_dwordx4 v140, s[40:43], s66 offen offset:0 nt lds
buffer_load_dwordx4 v141, s[40:43], s66 offen offset:1024 nt lds
buffer_load_dwordx4 v142, s[40:43], s66 offen offset:2048 nt lds
buffer_load_dwordx4 v143, s[40:43], s66 offen offset:3072 nt lds
L_vsel:
s_cmp_eq_u32 s34, 0
s_cbranch_scc1 L_vfirst
L_vchk:
v_xor_b32 v158, s76, v154
v_xor_b32 v159, s77, v155
v_xor_b32 v160, s78, v156
v_xor_b32 v161, s79, v157
v_or_b32 v76, v158, v159
v_or3_b32 v76, v76, v160, v161
v_mov_b32_dpp v72, v158 quad_perm:[0,1,0,1] row_mask:0xf bank_mask:0xf
v_mov_b32_dpp v73, v159 quad_perm:[0,1,0,1] row_mask:0xf bank_mask:0xf
v_mov_b32_dpp v74, v160 quad_perm:[0,1,0,1] row_mask:0xf bank_mask:0xf
v_mov_b32_dpp v75, v161 quad_perm:[0,1,0,1] row_mask:0xf bank_mask:0xf
v_mov_b32_dpp v144, v158 quad_perm:[2,3,2,3] row_mask:0xf bank_mask:0xf
v_mov_b32_dpp v145, v159 quad_perm:[2,3,2,3] row_mask:0xf bank_mask:0xf
v_mov_b32_dpp v146, v160 quad_perm:[2,3,2,3] row_mask:0xf bank_mask:0xf
v_mov_b32_dpp v147, v161 quad_perm:[2,3,2,3] row_mask:0xf bank_mask:0xf
v_and_b32 v76, 0xff, v76
v_cmp_ne_u32 vcc, 0, v76
s_cbranch_vccnz L_vretry
L_vok:
s_cmp_lg_u32 s49, 0
s_cbranch_scc1 L_vmax
v_add_u32 v163, s57, v162
s_mov_b32 exec_lo, 0x000f000f
s_mov_b32 exec_hi, 0x000f000f
global_load_dwordx4 v[154:157], v163, s[26:27] sc1 nt
s_mov_b64 exec, -1
L_vmax:
v_max3_f32 v76, v72, v73, v74
v_max3_f32 v77, v75, v144, v145
v_max3_f32 v76, v76, v146, v147
v_max_f32 v76, v76, v77
v_cmp_gt_f32 vcc, v76, v116
s_cbranch_vccz L_exp
s_branch L_newmax
L_vretry:
s_mov_b32 exec_lo, 0x000f000f
s_mov_b32 exec_hi, 0x000f000f
global_load_dwordx4 v[154:157], v163, s[26:27] sc1 nt
s_mov_b64 exec, -1
s_sub_u32 s60, s60, 1
s_waitcnt vmcnt(0)
s_cbranch_scc0 L_vchk
s_mov_b32 s60, 0
s_branch L_vok
L_vfirst:
s_mov_b32 s34, 1
s_cmp_lg_u32 s49, 0
s_cbranch_scc1 L_vs
v_add_u32 v163, s57, v162
s_mov_b32 exec_lo, 0x000f000f
s_mov_b32 exec_hi, 0x000f000f
global_load_dwordx4 v[154:157], v163, s[26:27] sc1 nt
s_mov_b64 exec, -1
s_branch L_vs
L_vend:
s_cmp_eq_u32 s45, 39
s_cbranch_scc1 L_vcl
s_mov_b32 s60, 20000
v_mov_b32 v154, s76
v_or_b32 v154, 0xff800000, v154
v_mov_b32 v155, s77
v_or_b32 v155, 0xff800000, v155
v_mov_b32 v156, s78
v_or_b32 v156, 0xff800000, v156
v_mov_b32 v157, s79
v_or_b32 v157, 0xff800000, v157
s_waitcnt vmcnt(8)
s_branch L_vdyn
L_vcl:
s_waitcnt vmcnt(0)
s_mov_b64 exec, 1
global_atomic_add v119, v120, v121, s[26:27] offset:128 sc0 sc1
s_mov_b64 exec, -1
s_branch L_viss
L_last:
s_cmp_ge_u32 s51, 70
s_cselect_b32 s50, s14, 0
s_mov_b32 s49, 1
s_cmp_ge_u32 s33, 9
s_cbranch_scc1 L_nowo
s_lshl2_add_u32 s51, s71, s3
s_mul_i32 s51, s51, 73728
s_lshl_b32 s52, s33, 7
s_add_u32 s51, s51, s52
s_add_u32 s36, s12, s51
s_addc_u32 s37, s13, 0
s_sub_u32 s38, 73728, s52
s_lshl_b32 s51, s3, 14
s_add_u32 s51, s51, 0x10000
s_add_u32 m0, s51, 0
s_mov_b32 s53, 0
buffer_load_dwordx4 v131, s[36:39], s53 offen offset:0 nt lds
s_mov_b32 s53, 8192
buffer_load_dwordx4 v131, s[36:39], s53 offen offset:1024 nt lds
s_mov_b32 s53, 16384
buffer_load_dwordx4 v131, s[36:39], s53 offen offset:2048 nt lds
s_mov_b32 s53, 24576
buffer_load_dwordx4 v131, s[36:39], s53 offen offset:3072 nt lds
s_add_u32 m0, s51, 4096
s_mov_b32 s53, 36864
buffer_load_dwordx4 v131, s[36:39], s53 offen offset:0 nt lds
s_mov_b32 s53, 45056
buffer_load_dwordx4 v131, s[36:39], s53 offen offset:1024 nt lds
s_mov_b32 s53, 53248
buffer_load_dwordx4 v131, s[36:39], s53 offen offset:2048 nt lds
s_mov_b32 s53, 61440
buffer_load_dwordx4 v131, s[36:39], s53 offen offset:3072 nt lds
s_cmp_eq_u32 s50, 0
s_cbranch_scc1 L_w8
s_lshl_b32 s51, s3, 14
s_add_u32 s51, s51, 0x12000
s_add_u32 m0, s51, 0
s_mov_b32 s53, 0
buffer_load_dwordx4 v131, s[16:19], s53 offen offset:0 nt lds
s_mov_b32 s53, 8192
buffer_load_dwordx4 v131, s[16:19], s53 offen offset:1024 nt lds
s_mov_b32 s53, 16384
buffer_load_dwordx4 v131, s[16:19], s53 offen offset:2048 nt lds
s_mov_b32 s53, 24576
buffer_load_dwordx4 v131, s[16:19], s53 offen offset:3072 nt lds
s_add_u32 m0, s51, 4096
s_mov_b32 s53, 36864
buffer_load_dwordx4 v131, s[16:19], s53 offen offset:0 nt lds
s_mov_b32 s53, 45056
buffer_load_dwordx4 v131, s[16:19], s53 offen offset:1024 nt lds
s_mov_b32 s53, 53248
buffer_load_dwordx4 v131, s[16:19], s53 offen offset:2048 nt lds
s_mov_b32 s53, 61440
buffer_load_dwordx4 v131, s[16:19], s53 offen offset:3072 nt lds
s_waitcnt vmcnt(16)
s_branch L_vsel
L_nowo:
s_cmp_eq_u32 s50, 0
s_cbranch_scc1 L_w0
s_lshl_b32 s51, s3, 14
s_add_u32 s51, s51, 0x12000
s_add_u32 m0, s51, 0
s_mov_b32 s53, 0
buffer_load_dwordx4 v131, s[16:19], s53 offen offset:0 nt lds
s_mov_b32 s53, 8192
buffer_load_dwordx4 v131, s[16:19], s53 offen offset:1024 nt lds
s_mov_b32 s53, 16384
buffer_load_dwordx4 v131, s[16:19], s53 offen offset:2048 nt lds
s_mov_b32 s53, 24576
buffer_load_dwordx4 v131, s[16:19], s53 offen offset:3072 nt lds
s_add_u32 m0, s51, 4096
s_mov_b32 s53, 36864
buffer_load_dwordx4 v131, s[16:19], s53 offen offset:0 nt lds
s_mov_b32 s53, 45056
buffer_load_dwordx4 v131, s[16:19], s53 offen offset:1024 nt lds
s_mov_b32 s53, 53248
buffer_load_dwordx4 v131, s[16:19], s53 offen offset:2048 nt lds
s_mov_b32 s53, 61440
buffer_load_dwordx4 v131, s[16:19], s53 offen offset:3072 nt lds
L_w8:
s_waitcnt vmcnt(8)
s_branch L_vsel
L_w0:
s_waitcnt vmcnt(0)
s_branch L_vsel
L_newmax:
v_mov_b32 v77, v76
s_nop 1
v_permlane32_swap_b32 v76, v77
v_max_f32 v76, v76, v77
v_mov_b32 v77, v76
s_nop 1
v_permlane16_swap_b32 v76, v77
v_max3_f32 v116, v116, v76, v77
v_mul_f32 v76, s55, v116
v_sub_f32 v78, v117, v76
v_exp_f32 v78, v78
v_mov_b32 v117, v76
v_mul_f32 v118, v118, v78
v_pk_mul_f32 v[84:85], v[84:85], v[78:79] op_sel_hi:[1,0]
v_pk_mul_f32 v[86:87], v[86:87], v[78:79] op_sel_hi:[1,0]
v_pk_mul_f32 v[88:89], v[88:89], v[78:79] op_sel_hi:[1,0]
v_pk_mul_f32 v[90:91], v[90:91], v[78:79] op_sel_hi:[1,0]
v_pk_mul_f32 v[92:93], v[92:93], v[78:79] op_sel_hi:[1,0]
v_pk_mul_f32 v[94:95], v[94:95], v[78:79] op_sel_hi:[1,0]
v_pk_mul_f32 v[96:97], v[96:97], v[78:79] op_sel_hi:[1,0]
v_pk_mul_f32 v[98:99], v[98:99], v[78:79] op_sel_hi:[1,0]
v_pk_mul_f32 v[100:101], v[100:101], v[78:79] op_sel_hi:[1,0]
v_pk_mul_f32 v[102:103], v[102:103], v[78:79] op_sel_hi:[1,0]
v_pk_mul_f32 v[104:105], v[104:105], v[78:79] op_sel_hi:[1,0]
v_pk_mul_f32 v[106:107], v[106:107], v[78:79] op_sel_hi:[1,0]
v_pk_mul_f32 v[108:109], v[108:109], v[78:79] op_sel_hi:[1,0]
v_pk_mul_f32 v[110:111], v[110:111], v[78:79] op_sel_hi:[1,0]
v_pk_mul_f32 v[112:113], v[112:113], v[78:79] op_sel_hi:[1,0]
v_pk_mul_f32 v[114:115], v[114:115], v[78:79] op_sel_hi:[1,0]
s_branch L_exp
L_newmax2:
v_mov_b32 v77, v76
s_nop 1
v_permlane32_swap_b32 v76, v77
v_max_f32 v76, v76, v77
v_mov_b32 v77, v76
s_nop 1
v_permlane16_swap_b32 v76, v77
v_max3_f32 v116, v116, v76, v77
v_mul_f32 v76, s55, v116
v_sub_f32 v78, v117, v76
v_exp_f32 v78, v78
v_mov_b32 v117, v76
v_mul_f32 v118, v118, v78
v_pk_mul_f32 v[84:85], v[84:85], v[78:79] op_sel_hi:[1,0]
v_pk_mul_f32 v[86:87], v[86:87], v[78:79] op_sel_hi:[1,0]
v_pk_mul_f32 v[88:89], v[88:89], v[78:79] op_sel_hi:[1,0]
v_pk_mul_f32 v[90:91], v[90:91], v[78:79] op_sel_hi:[1,0]
v_pk_mul_f32 v[92:93], v[92:93], v[78:79] op_sel_hi:[1,0]
v_pk_mul_f32 v[94:95], v[94:95], v[78:79] op_sel_hi:[1,0]
v_pk_mul_f32 v[96:97], v[96:97], v[78:79] op_sel_hi:[1,0]
v_pk_mul_f32 v[98:99], v[98:99], v[78:79] op_sel_hi:[1,0]
v_pk_mul_f32 v[100:101], v[100:101], v[78:79] op_sel_hi:[1,0]
v_pk_mul_f32 v[102:103], v[102:103], v[78:79] op_sel_hi:[1,0]
v_pk_mul_f32 v[104:105], v[104:105], v[78:79] op_sel_hi:[1,0]
v_pk_mul_f32 v[106:107], v[106:107], v[78:79] op_sel_hi:[1,0]
v_pk_mul_f32 v[108:109], v[108:109], v[78:79] op_sel_hi:[1,0]
v_pk_mul_f32 v[110:111], v[110:111], v[78:79] op_sel_hi:[1,0]
v_pk_mul_f32 v[112:113], v[112:113], v[78:79] op_sel_hi:[1,0]
v_pk_mul_f32 v[114:115], v[114:115], v[78:79] op_sel_hi:[1,0]
s_branch L_exp2
L_w3done:
s_cmp_ge_u32 s33, 9
s_cbranch_scc1 L_wo_skip
s_lshl2_add_u32 s51, s71, s3
s_mul_i32 s51, s51, 73728
s_lshl_b32 s52, s33, 7
s_add_u32 s51, s51, s52
s_add_u32 s36, s12, s51
s_addc_u32 s37, s13, 0
s_sub_u32 s38, 73728, s52
s_lshl_b32 s51, s3, 14
s_add_u32 s51, s51, 0x10000
s_add_u32 m0, s51, 0
s_mov_b32 s53, 0
buffer_load_dwordx4 v131, s[36:39], s53 offen offset:0 nt lds
s_mov_b32 s53, 8192
buffer_load_dwordx4 v131, s[36:39], s53 offen offset:1024 nt lds
s_mov_b32 s53, 16384
buffer_load_dwordx4 v131, s[36:39], s53 offen offset:2048 nt lds
s_mov_b32 s53, 24576
buffer_load_dwordx4 v131, s[36:39], s53 offen offset:3072 nt lds
s_add_u32 m0, s51, 4096
s_mov_b32 s53, 36864
buffer_load_dwordx4 v131, s[36:39], s53 offen offset:0 nt lds
s_mov_b32 s53, 45056
buffer_load_dwordx4 v131, s[36:39], s53 offen offset:1024 nt lds
s_mov_b32 s53, 53248
buffer_load_dwordx4 v131, s[36:39], s53 offen offset:2048 nt lds
s_mov_b32 s53, 61440
buffer_load_dwordx4 v131, s[36:39], s53 offen offset:3072 nt lds
s_branch L_wo_skip
L_done:
s_cmp_eq_u32 s14, s50
s_cbranch_scc1 L_nodn
s_lshl_b32 s51, s3, 14
s_add_u32 s51, s51, 0x12000
s_add_u32 m0, s51, 0
s_mov_b32 s53, 0
buffer_load_dwordx4 v131, s[16:19], s53 offen offset:0 nt lds
s_mov_b32 s53, 8192
buffer_load_dwordx4 v131, s[16:19], s53 offen offset:1024 nt lds
s_mov_b32 s53, 16384
buffer_load_dwordx4 v131, s[16:19], s53 offen offset:2048 nt lds
s_mov_b32 s53, 24576
buffer_load_dwordx4 v131, s[16:19], s53 offen offset:3072 nt lds
s_add_u32 m0, s51, 4096
s_mov_b32 s53, 36864
buffer_load_dwordx4 v131, s[16:19], s53 offen offset:0 nt lds
s_mov_b32 s53, 45056
buffer_load_dwordx4 v131, s[16:19], s53 offen offset:1024 nt lds
s_mov_b32 s53, 53248
buffer_load_dwordx4 v131, s[16:19], s53 offen offset:2048 nt lds
s_mov_b32 s53, 61440
buffer_load_dwordx4 v131, s[16:19], s53 offen offset:3072 nt lds
L_nodn:
v_mov_b32 v76, v118
v_and_b32 v78, 1, v0
v_lshlrev_b32 v79, 9, v78
v_permlane32_swap_b32 v118, v76
v_add_f32 v118, v118, v76
v_mov_b32 v76, v118
s_lshl_b32 s51, s3, 14
v_lshl_or_b32 v79, v1, 4, v79
v_permlane16_swap_b32 v118, v76
v_add_f32 v118, v118, v76
v_add_u32 v79, s51, v79
v_lshl_add_u32 v78, v78, 3, s51
s_mov_b32 exec_lo, 0x00030003
s_mov_b32 exec_hi, 0x00030003
ds_write_b128 v79, v[84:87] offset:0
ds_write_b128 v79, v[88:91] offset:64
ds_write_b128 v79, v[92:95] offset:128
ds_write_b128 v79, v[96:99] offset:192
ds_write_b128 v79, v[100:103] offset:256
ds_write_b128 v79, v[104:107] offset:320
ds_write_b128 v79, v[108:111] offset:384
ds_write_b128 v79, v[112:115] offset:448
ds_write_b32 v78, v117 offset:1024
ds_write_b32 v78, v118 offset:1028
s_mov_b64 exec, -1
L_wo_skip:
s_lshl_b32 s51, s3, 14
s_add_u32 m0, s51, 0x2000
s_cmp_ge_u32 s33, 9
s_waitcnt lgkmcnt(0)
s_barrier
L_post:
s_cbranch_scc1 L_dn_only
buffer_load_dwordx4 v4, s[72:75], 0 offen offset:0 sc1 lds
buffer_load_dwordx4 v5, s[72:75], 0 offen offset:1024 sc1 lds
buffer_load_dwordx4 v6, s[72:75], 0 offen offset:2048 sc1 lds
buffer_load_dwordx4 v7, s[72:75], 0 offen offset:3072 sc1 lds
global_load_dwordx2 v[72:73], v129, s[26:27] sc1
v_or_b32 v10, 0x2000, v10
v_or_b32 v11, 0x2000, v11
v_or_b32 v12, 0x2000, v12
v_or_b32 v13, 0x2000, v13
s_mov_b32 s60, 20000
s_cmp_lg_u32 s14, 0
s_cbranch_scc1 L_wo_bar
s_waitcnt vmcnt(5)
L_wo_bar:
s_waitcnt vmcnt(13)
s_barrier
ds_read_b64_tr_b16 v[40:41], v124 offset:0
ds_read_b64_tr_b16 v[42:43], v125 offset:0
ds_read_b64_tr_b16 v[44:45], v124 offset:4096
ds_read_b64_tr_b16 v[46:47], v125 offset:4096
ds_read_b64_tr_b16 v[48:49], v124 offset:16384
ds_read_b64_tr_b16 v[50:51], v125 offset:16384
ds_read_b64_tr_b16 v[52:53], v124 offset:20480
ds_read_b64_tr_b16 v[54:55], v125 offset:20480
ds_read_b64_tr_b16 v[56:57], v126 offset:0
ds_read_b64_tr_b16 v[58:59], v127 offset:0
ds_read_b64_tr_b16 v[60:61], v126 offset:4096
ds_read_b64_tr_b16 v[62:63], v127 offset:4096
ds_read_b64_tr_b16 v[64:65], v126 offset:16384
ds_read_b64_tr_b16 v[66:67], v127 offset:16384
ds_read_b64_tr_b16 v[68:69], v126 offset:20480
s_waitcnt lgkmcnt(14)
ds_read_b64_tr_b16 v[70:71], v127 offset:20480
s_waitcnt lgkmcnt(0)
s_mov_b32 s58, 0x000f000f
s_cbranch_scc1 L_down
L_po_poll:
s_waitcnt vmcnt(0)
L_po_chk:
ds_read_b128 v[24:27], v10
ds_read_b128 v[28:31], v11
ds_read_b128 v[32:35], v12
ds_read_b128 v[36:39], v13
v_max_u32 v76, v72, v73
s_waitcnt lgkmcnt(3)
v_max3_u32 v76, v76, v24, v25
v_max3_u32 v76, v76, v26, v27
s_waitcnt lgkmcnt(2)
v_max3_u32 v76, v76, v28, v29
v_max3_u32 v76, v76, v30, v31
s_waitcnt lgkmcnt(1)
v_max3_u32 v76, v76, v32, v33
v_max3_u32 v76, v76, v34, v35
s_waitcnt lgkmcnt(0)
v_max3_u32 v76, v76, v36, v37
v_max3_u32 v76, v76, v38, v39
v_cmp_eq_u32 vcc, -1, v76
s_cbranch_vccz L_po_ok
buffer_load_dwordx4 v4, s[72:75], 0 offen offset:0 sc1 lds
buffer_load_dwordx4 v5, s[72:75], 0 offen offset:1024 sc1 lds
buffer_load_dwordx4 v6, s[72:75], 0 offen offset:2048 sc1 lds
buffer_load_dwordx4 v7, s[72:75], 0 offen offset:3072 sc1 lds
global_load_dwordx2 v[72:73], v129, s[26:27] sc1
s_sub_u32 s60, s60, 1
s_cmp_lg_u32 s60, 0
s_cbranch_scc1 L_po_poll
L_po_ok:
v_mfma_f32_16x16x32_bf16 v[84:87], v[40:43], v[24:27], 0
v_mfma_f32_16x16x32_bf16 v[88:91], v[56:59], v[24:27], 0
v_mfma_f32_16x16x32_bf16 v[84:87], v[44:47], v[28:31], v[84:87]
v_mfma_f32_16x16x32_bf16 v[88:91], v[60:63], v[28:31], v[88:91]
v_mfma_f32_16x16x32_bf16 v[84:87], v[48:51], v[32:35], v[84:87]
v_mfma_f32_16x16x32_bf16 v[88:91], v[64:67], v[32:35], v[88:91]
v_mfma_f32_16x16x32_bf16 v[84:87], v[52:55], v[36:39], v[84:87]
v_mfma_f32_16x16x32_bf16 v[88:91], v[68:71], v[36:39], v[88:91]
v_max_f32_dpp v76, v72, v72 row_ror:8 row_mask:0xf bank_mask:0xf
s_nop 1
v_max_f32_dpp v76, v76, v76 row_ror:4 row_mask:0xf bank_mask:0xf
s_nop 1
v_max_f32_dpp v76, v76, v76 row_ror:2 row_mask:0xf bank_mask:0xf
v_sub_f32 v76, v72, v76
v_exp_f32 v76, v76
s_nop 0
v_mul_f32 v77, v76, v73
s_nop 1
v_add_f32_dpp v77, v77, v77 row_ror:8 row_mask:0xf bank_mask:0xf
s_nop 1
v_add_f32_dpp v77, v77, v77 row_ror:4 row_mask:0xf bank_mask:0xf
s_nop 1
v_add_f32_dpp v77, v77, v77 row_ror:2 row_mask:0xf bank_mask:0xf
v_rcp_f32 v77, v77
s_nop 0
v_mul_f32 v76, v76, v77
v_cndmask_b32 v92, v84, v88, s[62:63]
v_cndmask_b32 v96, v88, v84, s[62:63]
v_cndmask_b32 v93, v85, v89, s[62:63]
v_cndmask_b32 v97, v89, v85, s[62:63]
v_cndmask_b32 v94, v86, v90, s[62:63]
v_cndmask_b32 v98, v90, v86, s[62:63]
v_cndmask_b32 v95, v87, v91, s[62:63]
v_cndmask_b32 v99, v91, v87, s[62:63]
v_mul_f32 v96, v76, v96
v_mul_f32 v97, v76, v97
v_mul_f32 v98, v76, v98
v_mul_f32 v99, v76, v99
v_mul_f32 v92, v76, v92
v_mul_f32 v93, v76, v93
v_mul_f32 v94, v76, v94
v_mul_f32 v95, v76, v95
v_add_f32_dpp v92, v96, v92 quad_perm:[2,3,0,1] row_mask:0xf bank_mask:0xf
v_add_f32_dpp v93, v97, v93 quad_perm:[2,3,0,1] row_mask:0xf bank_mask:0xf
v_add_f32_dpp v94, v98, v94 quad_perm:[2,3,0,1] row_mask:0xf bank_mask:0xf
v_add_f32_dpp v95, v99, v95 quad_perm:[2,3,0,1] row_mask:0xf bank_mask:0xf
v_add_f32_dpp v92, v92, v92 row_ror:4 row_mask:0xf bank_mask:0xf
v_add_f32_dpp v93, v93, v93 row_ror:4 row_mask:0xf bank_mask:0xf
v_add_f32_dpp v94, v94, v94 row_ror:4 row_mask:0xf bank_mask:0xf
v_add_f32_dpp v95, v95, v95 row_ror:4 row_mask:0xf bank_mask:0xf
v_add_f32_dpp v92, v92, v92 row_ror:8 row_mask:0xf bank_mask:0xf
v_add_f32_dpp v93, v93, v93 row_ror:8 row_mask:0xf bank_mask:0xf
v_add_f32_dpp v94, v94, v94 row_ror:8 row_mask:0xf bank_mask:0xf
v_add_f32_dpp v95, v95, v95 row_ror:8 row_mask:0xf bank_mask:0xf
v_and_or_b32 v92, v92, v132, s76
v_and_or_b32 v93, v93, v132, s77
v_and_or_b32 v94, v94, v132, s78
v_and_or_b32 v95, v95, v132, s79
s_mov_b32 exec_lo, s58
s_mov_b32 exec_hi, s58
global_store_dwordx4 v130, v[92:95], s[26:27] sc1
L_main_end:
s_endpgm
L_dn_only:
s_cmp_eq_u32 s14, 0
s_cbranch_scc1 L_main_end
s_waitcnt vmcnt(0)
L_down:
v_and_b32 v22, 1, v0
v_lshl_or_b32 v22, v1, 1, v22
v_lshlrev_b32 v18, 5, v22
ds_read_b128 v[156:159], v18 offset:49152
ds_read_b128 v[160:163], v18 offset:49168
s_lshl_b32 s51, s3, 14
s_add_u32 s51, s51, 0x12000
v_lshrrev_b32 v22, 2, v0
v_bfe_u32 v23, v0, 3, 2
v_lshlrev_b32 v23, 5, v23
v_lshl_or_b32 v23, v22, 7, v23
v_and_b32 v22, 3, v0
v_lshl_or_b32 v23, v22, 3, v23
v_add_u32 v14, s51, v23
v_xor_b32 v15, 32, v14
v_xor_b32 v16, 64, v14
v_xor_b32 v17, 96, v14
v_bfe_u32 v23, v0, 2, 1
v_lshlrev_b32 v23, 8, v23
v_lshl_or_b32 v23, v1, 6, v23
v_lshl_or_b32 v23, v22, 4, v23
v_add_u32 v19, s15, v23
s_mov_b32 s34, 0xc0c0c0c
s_mov_b32 s35, 0xc0c0c0c
s_mov_b32 s64, 0x30303030
s_mov_b32 s65, 0x30303030
s_mov_b32 s48, 0xc0c0c0c0
s_mov_b32 s49, 0xc0c0c0c0
s_waitcnt vmcnt(5) lgkmcnt(0)
ds_read_b64_tr_b16 v[100:101], v14 offset:0
ds_read_b64_tr_b16 v[102:103], v14 offset:2048
ds_read_b64_tr_b16 v[104:105], v15 offset:0
ds_read_b64_tr_b16 v[106:107], v15 offset:2048
ds_read_b64_tr_b16 v[108:109], v16 offset:0
ds_read_b64_tr_b16 v[110:111], v16 offset:2048
ds_read_b64_tr_b16 v[112:113], v17 offset:0
ds_read_b64_tr_b16 v[114:115], v17 offset:2048
ds_read_b64_tr_b16 v[84:85], v14 offset:4096
ds_read_b64_tr_b16 v[86:87], v14 offset:6144
ds_read_b64_tr_b16 v[88:89], v15 offset:4096
ds_read_b64_tr_b16 v[90:91], v15 offset:6144
ds_read_b64_tr_b16 v[92:93], v16 offset:4096
ds_read_b64_tr_b16 v[94:95], v16 offset:6144
ds_read_b64_tr_b16 v[96:97], v17 offset:4096
s_waitcnt lgkmcnt(14)
ds_read_b64_tr_b16 v[98:99], v17 offset:6144
s_waitcnt lgkmcnt(8)
v_mfma_f32_16x16x32_bf16 v[136:139], v[100:103], v[156:159], 0
v_mfma_f32_16x16x32_bf16 v[140:143], v[104:107], v[156:159], 0
v_mfma_f32_16x16x32_bf16 v[144:147], v[108:111], v[156:159], 0
v_mfma_f32_16x16x32_bf16 v[148:151], v[112:115], v[156:159], 0
s_waitcnt lgkmcnt(0)
v_mfma_f32_16x16x32_bf16 v[136:139], v[84:87], v[160:163], v[136:139]
v_mfma_f32_16x16x32_bf16 v[140:143], v[88:91], v[160:163], v[140:143]
v_mfma_f32_16x16x32_bf16 v[144:147], v[92:95], v[160:163], v[144:147]
v_mfma_f32_16x16x32_bf16 v[148:151], v[96:99], v[160:163], v[148:151]
s_nop 7
s_nop 0
v_cndmask_b32 v152, v136, v140, s[34:35]
v_cndmask_b32 v153, v137, v141, s[34:35]
v_cndmask_b32 v154, v138, v142, s[34:35]
v_cndmask_b32 v155, v139, v143, s[34:35]
v_cndmask_b32 v152, v152, v144, s[64:65]
v_cndmask_b32 v153, v153, v145, s[64:65]
v_cndmask_b32 v154, v154, v146, s[64:65]
v_cndmask_b32 v155, v155, v147, s[64:65]
v_cndmask_b32 v152, v152, v148, s[48:49]
v_cndmask_b32 v153, v153, v149, s[48:49]
v_cndmask_b32 v154, v154, v150, s[48:49]
v_cndmask_b32 v155, v155, v151, s[48:49]
v_and_or_b32 v152, v152, v132, s76
v_and_or_b32 v153, v153, v132, s77
v_and_or_b32 v154, v154, v132, s78
v_and_or_b32 v155, v155, v132, s79
s_mov_b32 exec_lo, 0x00ff00ff
s_mov_b32 exec_hi, 0x00ff00ff
global_store_dwordx4 v19, v[152:155], s[26:27] sc1
s_mov_b64 exec, -1
s_cmp_ge_u32 s33, 9
s_cbranch_scc1 L_main_end
s_waitcnt vmcnt(1)
s_branch L_po_chk
L_ffn:
s_cmp_lt_u32 s29, 8
s_cselect_b32 s51, 6, 7
s_cselect_b32 s52, 224, 0
s_sub_u32 s52, s52, 56
s_mul_i32 s66, s29, s51
s_add_u32 s66, s66, s52
s_add_u32 s66, s66, s69
s_cmp_lt_u32 s69, s51
s_cselect_b32 s66, s66, 216
s_mul_i32 s67, s66, 171
s_lshr_b32 s67, s67, 9
s_mul_i32 s51, s67, 3
s_sub_u32 s68, s66, s51
v_lshrrev_b32 v22, 3, v0
v_and_b32 v23, 6, v22
v_xor_b32 v23, v0, v23
v_and_b32 v23, 7, v23
v_lshlrev_b32 v23, 4, v23
s_movk_i32 s51, 9216
v_mad_u32_u24 v120, v22, s51, v23
s_movk_i32 s51, 1152
v_mad_u32_u24 v121, v22, s51, v23
s_lshr_b32 s52, s67, 1
s_lshl_b32 s52, s52, 8
s_sub_u32 s38, 5308416, s52
s_sub_u32 s42, s38, 128
s_mul_i32 s44, s68, 1769472
s_mul_i32 s45, s68, 384
s_mul_i32 s51, s67, 73728
s_mov_b32 s74, 73728
s_mov_b32 s75, 0x20000
s_waitcnt lgkmcnt(0)
s_bitcmp1_b32 s67, 0
s_cselect_b32 s36, s18, s16
s_cselect_b32 s37, s19, s17
s_add_u32 s36, s36, s52
s_addc_u32 s37, s37, 0
s_add_u32 s40, s36, 128
s_addc_u32 s41, s37, 0
s_add_u32 s72, s20, s51
s_addc_u32 s73, s21, 0
s_load_dword s70, s[26:27], 0x44000
s_cmp_ge_u32 s66, 216
s_barrier
s_cbranch_scc1 L_fill_end
s_xor_b32 s54, s47, 0x0
s_xor_b32 s55, s47, 0x2000
s_add_u32 m0, s54, 0
s_add_u32 s53, s44, 0
buffer_load_dwordx4 v120, s[36:39], s53 offen nt lds
s_add_u32 m0, s55, 0
s_add_u32 s53, s44, 0
buffer_load_dwordx4 v120, s[40:43], s53 offen nt lds
s_add_u32 m0, s54, 1024
s_add_u32 s53, s44, 73728
buffer_load_dwordx4 v120, s[36:39], s53 offen nt lds
s_add_u32 m0, s55, 1024
s_add_u32 s53, s44, 73728
buffer_load_dwordx4 v120, s[40:43], s53 offen nt lds
s_add_u32 m0, s54, 2048
s_add_u32 s53, s44, 147456
buffer_load_dwordx4 v120, s[36:39], s53 offen nt lds
s_add_u32 m0, s55, 2048
s_add_u32 s53, s44, 147456
buffer_load_dwordx4 v120, s[40:43], s53 offen nt lds
s_add_u32 m0, s54, 3072
s_add_u32 s53, s44, 221184
buffer_load_dwordx4 v120, s[36:39], s53 offen nt lds
s_add_u32 m0, s55, 3072
s_add_u32 s53, s44, 221184
buffer_load_dwordx4 v120, s[40:43], s53 offen nt lds
s_add_u32 m0, s54, 4096
s_add_u32 s53, s44, 294912
buffer_load_dwordx4 v120, s[36:39], s53 offen nt lds
s_add_u32 m0, s55, 4096
s_add_u32 s53, s44, 294912
buffer_load_dwordx4 v120, s[40:43], s53 offen nt lds
s_add_u32 m0, s54, 5120
s_add_u32 s53, s44, 368640
buffer_load_dwordx4 v120, s[36:39], s53 offen nt lds
s_add_u32 m0, s55, 5120
s_add_u32 s53, s44, 368640
buffer_load_dwordx4 v120, s[40:43], s53 offen nt lds
s_add_u32 m0, s54, 6144
s_add_u32 s53, s44, 442368
buffer_load_dwordx4 v120, s[36:39], s53 offen nt lds
s_add_u32 m0, s55, 6144
s_add_u32 s53, s44, 442368
buffer_load_dwordx4 v120, s[40:43], s53 offen nt lds
s_add_u32 m0, s54, 7168
s_add_u32 s53, s44, 516096
buffer_load_dwordx4 v120, s[36:39], s53 offen nt lds
s_add_u32 m0, s55, 7168
s_add_u32 s53, s44, 516096
buffer_load_dwordx4 v120, s[40:43], s53 offen nt lds
s_add_u32 s44, s44, 589824
s_xor_b32 s54, s47, 0x10000
s_xor_b32 s55, s47, 0x12000
s_add_u32 m0, s54, 0
s_add_u32 s53, s44, 0
buffer_load_dwordx4 v120, s[36:39], s53 offen nt lds
s_add_u32 m0, s55, 0
s_add_u32 s53, s44, 0
buffer_load_dwordx4 v120, s[40:43], s53 offen nt lds
s_add_u32 m0, s54, 1024
s_add_u32 s53, s44, 73728
buffer_load_dwordx4 v120, s[36:39], s53 offen nt lds
s_add_u32 m0, s55, 1024
s_add_u32 s53, s44, 73728
buffer_load_dwordx4 v120, s[40:43], s53 offen nt lds
s_add_u32 m0, s54, 2048
s_add_u32 s53, s44, 147456
buffer_load_dwordx4 v120, s[36:39], s53 offen nt lds
s_add_u32 m0, s55, 2048
s_add_u32 s53, s44, 147456
buffer_load_dwordx4 v120, s[40:43], s53 offen nt lds
s_add_u32 m0, s54, 3072
s_add_u32 s53, s44, 221184
buffer_load_dwordx4 v120, s[36:39], s53 offen nt lds
s_add_u32 m0, s55, 3072
s_add_u32 s53, s44, 221184
buffer_load_dwordx4 v120, s[40:43], s53 offen nt lds
s_add_u32 m0, s54, 4096
s_add_u32 s53, s44, 294912
buffer_load_dwordx4 v120, s[36:39], s53 offen nt lds
s_add_u32 m0, s55, 4096
s_add_u32 s53, s44, 294912
buffer_load_dwordx4 v120, s[40:43], s53 offen nt lds
s_add_u32 m0, s54, 5120
s_add_u32 s53, s44, 368640
buffer_load_dwordx4 v120, s[36:39], s53 offen nt lds
s_add_u32 m0, s55, 5120
s_add_u32 s53, s44, 368640
buffer_load_dwordx4 v120, s[40:43], s53 offen nt lds
s_add_u32 m0, s54, 6144
s_add_u32 s53, s44, 442368
buffer_load_dwordx4 v120, s[36:39], s53 offen nt lds
s_add_u32 m0, s55, 6144
s_add_u32 s53, s44, 442368
buffer_load_dwordx4 v120, s[40:43], s53 offen nt lds
s_add_u32 m0, s54, 7168
s_add_u32 s53, s44, 516096
buffer_load_dwordx4 v120, s[36:39], s53 offen nt lds
s_add_u32 m0, s55, 7168
s_add_u32 s53, s44, 516096
buffer_load_dwordx4 v120, s[40:43], s53 offen nt lds
s_add_u32 s44, s44, 589824
v_lshrrev_b32 v22, 2, v0
v_bfe_u32 v23, v0, 3, 2
v_lshlrev_b32 v23, 5, v23
v_lshl_or_b32 v23, v22, 7, v23
v_and_b32 v22, 3, v0
v_lshl_or_b32 v23, v22, 3, v23
v_add_u32 v136, s47, v23
v_xor_b32 v137, 32, v136
v_xor_b32 v138, 64, v136
v_xor_b32 v139, 96, v136
v_and_b32 v22, 1, v0
v_mul_u32_u24 v23, 1152, v22
v_lshl_add_u32 v23, v1, 3, v23
s_add_u32 s51, s45, 0x24800
v_add_u32 v122, s51, v23
v_lshl_or_b32 v22, v1, 1, v22
v_lshl_add_u32 v124, v22, 4, s47
v_lshrrev_b32 v23, 1, v2
v_lshl_add_u32 v125, v23, 7, v124
v_lshl_add_u32 v126, v22, 5, s47
v_lshl_add_u32 v127, v23, 3, v126
s_mul_i32 s51, s67, 3072
s_add_u32 s51, s51, 0x100000
v_lshl_add_u32 v128, v0, 4, s51
s_lshl_b32 s51, s68, 10
v_add_u32 v129, s51, v128
s_and_b32 s51, s67, 1
s_mul_i32 s51, s51, 2944
v_bfe_u32 v22, v0, 3, 1
v_mul_u32_u24 v22, 2944, v22
v_subrev_u32 v22, s51, v22
v_add_u32 v128, v22, v128
s_mul_i32 s51, s67, 4608
s_lshl2_add_u32 s51, s45, s51
s_add_u32 s51, s51, 0x80000
v_bfe_u32 v22, v0, 2, 1
v_lshlrev_b32 v22, 8, v22
v_lshl_or_b32 v22, v1, 6, v22
v_and_b32 v23, 3, v0
v_lshl_or_b32 v22, v23, 4, v22
v_add_u32 v135, s51, v22
v_mov_b32 v132, 0xffffff00
s_mov_b32 s56, 0xffff0000
s_mov_b32 s58, 0x0c0c0c0c
s_mov_b32 s59, 0x0c0c0c0c
s_mov_b32 s64, 0x30303030
s_mov_b32 s65, 0x30303030
s_mov_b32 s62, 0xc0c0c0c0
s_mov_b32 s63, 0xc0c0c0c0
s_mov_b32 s60, 0x400000
v_mov_b32 v76, 0x25300
L_xwait:
ds_read_b32 v77, v76
s_sub_u32 s60, s60, 1
s_cbranch_scc1 L_xwait_out
s_waitcnt lgkmcnt(0)
v_cmp_gt_u32 vcc, 1, v77
s_cbranch_vccnz L_xwait
L_xwait_out:
s_waitcnt lgkmcnt(0)
s_and_b32 s51, s70, 0x80808080
s_and_b32 s70, s70, 0x7f7f7f7f
s_add_u32 s70, s70, 0x04030201
s_xor_b32 s70, s70, s51
s_bfe_u32 s76, s70, 0x80000
s_bfe_u32 s77, s70, 0x80008
s_bfe_u32 s78, s70, 0x80010
s_bfe_u32 s79, s70, 0x80018
ds_read_b64 v[24:25], v122 offset:0
ds_read_b64 v[26:27], v122 offset:32
ds_read_b64 v[28:29], v122 offset:64
ds_read_b64 v[30:31], v122 offset:96
s_waitcnt vmcnt(16)
ds_read_b64_tr_b16 v[40:41], v136 offset:0
ds_read_b64_tr_b16 v[42:43], v136 offset:2048
ds_read_b64_tr_b16 v[44:45], v137 offset:0
ds_read_b64_tr_b16 v[46:47], v137 offset:2048
ds_read_b64_tr_b16 v[48:49], v138 offset:0
ds_read_b64_tr_b16 v[50:51], v138 offset:2048
ds_read_b64_tr_b16 v[52:53], v139 offset:0
ds_read_b64_tr_b16 v[54:55], v139 offset:2048
ds_read_b64_tr_b16 v[56:57], v136 offset:4096
ds_read_b64_tr_b16 v[58:59], v136 offset:6144
ds_read_b64_tr_b16 v[60:61], v137 offset:4096
s_waitcnt lgkmcnt(14)
ds_read_b64_tr_b16 v[62:63], v137 offset:6144
s_waitcnt lgkmcnt(14)
ds_read_b64_tr_b16 v[64:65], v138 offset:4096
s_waitcnt lgkmcnt(14)
ds_read_b64_tr_b16 v[66:67], v138 offset:6144
s_waitcnt lgkmcnt(14)
ds_read_b64_tr_b16 v[68:69], v139 offset:4096
s_waitcnt lgkmcnt(14)
ds_read_b64_tr_b16 v[70:71], v139 offset:6144
s_waitcnt lgkmcnt(8)
v_mfma_f32_16x16x32_bf16 v[84:87], v[40:43], v[24:27], 0
v_mfma_f32_16x16x32_bf16 v[88:91], v[44:47], v[24:27], 0
v_mfma_f32_16x16x32_bf16 v[92:95], v[48:51], v[24:27], 0
v_mfma_f32_16x16x32_bf16 v[96:99], v[52:55], v[24:27], 0
s_waitcnt lgkmcnt(0)
v_mfma_f32_16x16x32_bf16 v[84:87], v[56:59], v[28:31], v[84:87]
v_mfma_f32_16x16x32_bf16 v[88:91], v[60:63], v[28:31], v[88:91]
v_mfma_f32_16x16x32_bf16 v[92:95], v[64:67], v[28:31], v[92:95]
v_mfma_f32_16x16x32_bf16 v[96:99], v[68:71], v[28:31], v[96:99]
s_waitcnt vmcnt(16)
ds_read_b64_tr_b16 v[40:41], v136 offset:8192
ds_read_b64_tr_b16 v[42:43], v136 offset:10240
ds_read_b64_tr_b16 v[44:45], v137 offset:8192
ds_read_b64_tr_b16 v[46:47], v137 offset:10240
ds_read_b64_tr_b16 v[48:49], v138 offset:8192
ds_read_b64_tr_b16 v[50:51], v138 offset:10240
ds_read_b64_tr_b16 v[52:53], v139 offset:8192
ds_read_b64_tr_b16 v[54:55], v139 offset:10240
ds_read_b64_tr_b16 v[56:57], v136 offset:12288
ds_read_b64_tr_b16 v[58:59], v136 offset:14336
ds_read_b64_tr_b16 v[60:61], v137 offset:12288
ds_read_b64_tr_b16 v[62:63], v137 offset:14336
ds_read_b64_tr_b16 v[64:65], v138 offset:12288
ds_read_b64_tr_b16 v[66:67], v138 offset:14336
ds_read_b64_tr_b16 v[68:69], v139 offset:12288
s_waitcnt lgkmcnt(14)
ds_read_b64_tr_b16 v[70:71], v139 offset:14336
s_waitcnt lgkmcnt(8)
v_mfma_f32_16x16x32_bf16 v[100:103], v[40:43], v[24:27], 0
v_mfma_f32_16x16x32_bf16 v[104:107], v[44:47], v[24:27], 0
v_mfma_f32_16x16x32_bf16 v[108:111], v[48:51], v[24:27], 0
v_mfma_f32_16x16x32_bf16 v[112:115], v[52:55], v[24:27], 0
s_waitcnt lgkmcnt(0)
v_mfma_f32_16x16x32_bf16 v[100:103], v[56:59], v[28:31], v[100:103]
v_mfma_f32_16x16x32_bf16 v[104:107], v[60:63], v[28:31], v[104:107]
v_mfma_f32_16x16x32_bf16 v[108:111], v[64:67], v[28:31], v[108:111]
v_mfma_f32_16x16x32_bf16 v[112:115], v[68:71], v[28:31], v[112:115]
v_xor_b32 v136, 0x10000, v136
v_xor_b32 v137, 0x10000, v137
v_xor_b32 v138, 0x10000, v138
v_xor_b32 v139, 0x10000, v139
s_xor_b32 s54, s47, 0x0
s_xor_b32 s55, s47, 0x2000
s_add_u32 m0, s54, 0
s_add_u32 s53, s44, 0
buffer_load_dwordx4 v120, s[36:39], s53 offen nt lds
s_add_u32 m0, s55, 0
s_add_u32 s53, s44, 0
buffer_load_dwordx4 v120, s[40:43], s53 offen nt lds
s_add_u32 m0, s54, 1024
s_add_u32 s53, s44, 73728
buffer_load_dwordx4 v120, s[36:39], s53 offen nt lds
s_add_u32 m0, s55, 1024
s_add_u32 s53, s44, 73728
buffer_load_dwordx4 v120, s[40:43], s53 offen nt lds
s_add_u32 m0, s54, 2048
s_add_u32 s53, s44, 147456
buffer_load_dwordx4 v120, s[36:39], s53 offen nt lds
s_add_u32 m0, s55, 2048
s_add_u32 s53, s44, 147456
buffer_load_dwordx4 v120, s[40:43], s53 offen nt lds
s_add_u32 m0, s54, 3072
s_add_u32 s53, s44, 221184
buffer_load_dwordx4 v120, s[36:39], s53 offen nt lds
s_add_u32 m0, s55, 3072
s_add_u32 s53, s44, 221184
buffer_load_dwordx4 v120, s[40:43], s53 offen nt lds
s_add_u32 m0, s54, 4096
s_add_u32 s53, s44, 294912
buffer_load_dwordx4 v120, s[36:39], s53 offen nt lds
s_add_u32 m0, s55, 4096
s_add_u32 s53, s44, 294912
buffer_load_dwordx4 v120, s[40:43], s53 offen nt lds
s_add_u32 m0, s54, 5120
s_add_u32 s53, s44, 368640
buffer_load_dwordx4 v120, s[36:39], s53 offen nt lds
s_add_u32 m0, s55, 5120
s_add_u32 s53, s44, 368640
buffer_load_dwordx4 v120, s[40:43], s53 offen nt lds
s_add_u32 m0, s54, 6144
s_add_u32 s53, s44, 442368
buffer_load_dwordx4 v120, s[36:39], s53 offen nt lds
s_add_u32 m0, s55, 6144
s_add_u32 s53, s44, 442368
buffer_load_dwordx4 v120, s[40:43], s53 offen nt lds
s_add_u32 m0, s54, 7168
s_add_u32 s53, s44, 516096
buffer_load_dwordx4 v120, s[36:39], s53 offen nt lds
s_add_u32 m0, s55, 7168
s_add_u32 s53, s44, 516096
buffer_load_dwordx4 v120, s[40:43], s53 offen nt lds
s_add_u32 s44, s44, 589824
ds_read_b64 v[24:25], v122 offset:128
ds_read_b64 v[26:27], v122 offset:160
ds_read_b64 v[28:29], v122 offset:192
ds_read_b64 v[30:31], v122 offset:224
s_waitcnt vmcnt(16)
ds_read_b64_tr_b16 v[40:41], v136 offset:0
ds_read_b64_tr_b16 v[42:43], v136 offset:2048
ds_read_b64_tr_b16 v[44:45], v137 offset:0
ds_read_b64_tr_b16 v[46:47], v137 offset:2048
ds_read_b64_tr_b16 v[48:49], v138 offset:0
ds_read_b64_tr_b16 v[50:51], v138 offset:2048
ds_read_b64_tr_b16 v[52:53], v139 offset:0
ds_read_b64_tr_b16 v[54:55], v139 offset:2048
ds_read_b64_tr_b16 v[56:57], v136 offset:4096
ds_read_b64_tr_b16 v[58:59], v136 offset:6144
ds_read_b64_tr_b16 v[60:61], v137 offset:4096
s_waitcnt lgkmcnt(14)
ds_read_b64_tr_b16 v[62:63], v137 offset:6144
s_waitcnt lgkmcnt(14)
ds_read_b64_tr_b16 v[64:65], v138 offset:4096
s_waitcnt lgkmcnt(14)
ds_read_b64_tr_b16 v[66:67], v138 offset:6144
s_waitcnt lgkmcnt(14)
ds_read_b64_tr_b16 v[68:69], v139 offset:4096
s_waitcnt lgkmcnt(14)
ds_read_b64_tr_b16 v[70:71], v139 offset:6144
s_waitcnt lgkmcnt(8)
v_mfma_f32_16x16x32_bf16 v[84:87], v[40:43], v[24:27], v[84:87]
v_mfma_f32_16x16x32_bf16 v[88:91], v[44:47], v[24:27], v[88:91]
v_mfma_f32_16x16x32_bf16 v[92:95], v[48:51], v[24:27], v[92:95]
v_mfma_f32_16x16x32_bf16 v[96:99], v[52:55], v[24:27], v[96:99]
s_waitcnt lgkmcnt(0)
v_mfma_f32_16x16x32_bf16 v[84:87], v[56:59], v[28:31], v[84:87]
v_mfma_f32_16x16x32_bf16 v[88:91], v[60:63], v[28:31], v[88:91]
v_mfma_f32_16x16x32_bf16 v[92:95], v[64:67], v[28:31], v[92:95]
v_mfma_f32_16x16x32_bf16 v[96:99], v[68:71], v[28:31], v[96:99]
s_waitcnt vmcnt(16)
ds_read_b64_tr_b16 v[40:41], v136 offset:8192
ds_read_b64_tr_b16 v[42:43], v136 offset:10240
ds_read_b64_tr_b16 v[44:45], v137 offset:8192
ds_read_b64_tr_b16 v[46:47], v137 offset:10240
ds_read_b64_tr_b16 v[48:49], v138 offset:8192
ds_read_b64_tr_b16 v[50:51], v138 offset:10240
ds_read_b64_tr_b16 v[52:53], v139 offset:8192
ds_read_b64_tr_b16 v[54:55], v139 offset:10240
ds_read_b64_tr_b16 v[56:57], v136 offset:12288
ds_read_b64_tr_b16 v[58:59], v136 offset:14336
ds_read_b64_tr_b16 v[60:61], v137 offset:12288
ds_read_b64_tr_b16 v[62:63], v137 offset:14336
ds_read_b64_tr_b16 v[64:65], v138 offset:12288
ds_read_b64_tr_b16 v[66:67], v138 offset:14336
ds_read_b64_tr_b16 v[68:69], v139 offset:12288
s_waitcnt lgkmcnt(14)
ds_read_b64_tr_b16 v[70:71], v139 offset:14336
s_waitcnt lgkmcnt(8)
v_mfma_f32_16x16x32_bf16 v[100:103], v[40:43], v[24:27], v[100:103]
v_mfma_f32_16x16x32_bf16 v[104:107], v[44:47], v[24:27], v[104:107]
v_mfma_f32_16x16x32_bf16 v[108:111], v[48:51], v[24:27], v[108:111]
v_mfma_f32_16x16x32_bf16 v[112:115], v[52:55], v[24:27], v[112:115]
s_waitcnt lgkmcnt(0)
v_mfma_f32_16x16x32_bf16 v[100:103], v[56:59], v[28:31], v[100:103]
v_mfma_f32_16x16x32_bf16 v[104:107], v[60:63], v[28:31], v[104:107]
v_mfma_f32_16x16x32_bf16 v[108:111], v[64:67], v[28:31], v[108:111]
v_mfma_f32_16x16x32_bf16 v[112:115], v[68:71], v[28:31], v[112:115]
v_xor_b32 v136, 0x10000, v136
v_xor_b32 v137, 0x10000, v137
v_xor_b32 v138, 0x10000, v138
v_xor_b32 v139, 0x10000, v139
ds_read_b64 v[24:25], v122 offset:256
ds_read_b64 v[26:27], v122 offset:288
ds_read_b64 v[28:29], v122 offset:320
ds_read_b64 v[30:31], v122 offset:352
s_waitcnt vmcnt(0)
ds_read_b64_tr_b16 v[40:41], v136 offset:0
ds_read_b64_tr_b16 v[42:43], v136 offset:2048
ds_read_b64_tr_b16 v[44:45], v137 offset:0
ds_read_b64_tr_b16 v[46:47], v137 offset:2048
ds_read_b64_tr_b16 v[48:49], v138 offset:0
ds_read_b64_tr_b16 v[50:51], v138 offset:2048
ds_read_b64_tr_b16 v[52:53], v139 offset:0
ds_read_b64_tr_b16 v[54:55], v139 offset:2048
ds_read_b64_tr_b16 v[56:57], v136 offset:4096
ds_read_b64_tr_b16 v[58:59], v136 offset:6144
ds_read_b64_tr_b16 v[60:61], v137 offset:4096
s_waitcnt lgkmcnt(14)
ds_read_b64_tr_b16 v[62:63], v137 offset:6144
s_waitcnt lgkmcnt(14)
ds_read_b64_tr_b16 v[64:65], v138 offset:4096
s_waitcnt lgkmcnt(14)
ds_read_b64_tr_b16 v[66:67], v138 offset:6144
s_waitcnt lgkmcnt(14)
ds_read_b64_tr_b16 v[68:69], v139 offset:4096
s_waitcnt lgkmcnt(14)
ds_read_b64_tr_b16 v[70:71], v139 offset:6144
s_waitcnt lgkmcnt(8)
v_mfma_f32_16x16x32_bf16 v[84:87], v[40:43], v[24:27], v[84:87]
v_mfma_f32_16x16x32_bf16 v[88:91], v[44:47], v[24:27], v[88:91]
v_mfma_f32_16x16x32_bf16 v[92:95], v[48:51], v[24:27], v[92:95]
v_mfma_f32_16x16x32_bf16 v[96:99], v[52:55], v[24:27], v[96:99]
s_waitcnt lgkmcnt(0)
v_mfma_f32_16x16x32_bf16 v[84:87], v[56:59], v[28:31], v[84:87]
v_mfma_f32_16x16x32_bf16 v[88:91], v[60:63], v[28:31], v[88:91]
v_mfma_f32_16x16x32_bf16 v[92:95], v[64:67], v[28:31], v[92:95]
v_mfma_f32_16x16x32_bf16 v[96:99], v[68:71], v[28:31], v[96:99]
s_waitcnt vmcnt(0)
ds_read_b64_tr_b16 v[40:41], v136 offset:8192
ds_read_b64_tr_b16 v[42:43], v136 offset:10240
ds_read_b64_tr_b16 v[44:45], v137 offset:8192
ds_read_b64_tr_b16 v[46:47], v137 offset:10240
ds_read_b64_tr_b16 v[48:49], v138 offset:8192
ds_read_b64_tr_b16 v[50:51], v138 offset:10240
ds_read_b64_tr_b16 v[52:53], v139 offset:8192
ds_read_b64_tr_b16 v[54:55], v139 offset:10240
ds_read_b64_tr_b16 v[56:57], v136 offset:12288
ds_read_b64_tr_b16 v[58:59], v136 offset:14336
ds_read_b64_tr_b16 v[60:61], v137 offset:12288
ds_read_b64_tr_b16 v[62:63], v137 offset:14336
ds_read_b64_tr_b16 v[64:65], v138 offset:12288
ds_read_b64_tr_b16 v[66:67], v138 offset:14336
ds_read_b64_tr_b16 v[68:69], v139 offset:12288
s_waitcnt lgkmcnt(14)
ds_read_b64_tr_b16 v[70:71], v139 offset:14336
s_waitcnt lgkmcnt(8)
v_mfma_f32_16x16x32_bf16 v[100:103], v[40:43], v[24:27], v[100:103]
v_mfma_f32_16x16x32_bf16 v[104:107], v[44:47], v[24:27], v[104:107]
v_mfma_f32_16x16x32_bf16 v[108:111], v[48:51], v[24:27], v[108:111]
v_mfma_f32_16x16x32_bf16 v[112:115], v[52:55], v[24:27], v[112:115]
s_waitcnt lgkmcnt(0)
v_mfma_f32_16x16x32_bf16 v[100:103], v[56:59], v[28:31], v[100:103]
v_mfma_f32_16x16x32_bf16 v[104:107], v[60:63], v[28:31], v[104:107]
v_mfma_f32_16x16x32_bf16 v[108:111], v[64:67], v[28:31], v[108:111]
v_mfma_f32_16x16x32_bf16 v[112:115], v[68:71], v[28:31], v[112:115]
v_xor_b32 v136, 0x10000, v136
v_xor_b32 v137, 0x10000, v137
v_xor_b32 v138, 0x10000, v138
v_xor_b32 v139, 0x10000, v139
s_mov_b32 exec_lo, 0x00030003
s_mov_b32 exec_hi, 0x00030003
ds_write_b128 v124, v[84:87] offset:0
ds_write_b128 v124, v[88:91] offset:128
ds_write_b128 v124, v[92:95] offset:256
ds_write_b128 v124, v[96:99] offset:384
ds_write_b128 v124, v[100:103] offset:512
ds_write_b128 v124, v[104:107] offset:640
ds_write_b128 v124, v[108:111] offset:768
ds_write_b128 v124, v[112:115] offset:896
s_mov_b64 exec, -1
ds_read_b128 v[144:147], v125
s_mov_b32 s60, 20000
s_waitcnt lgkmcnt(0)
v_and_or_b32 v144, v144, v132, s76
v_and_or_b32 v145, v145, v132, s77
v_and_or_b32 v146, v146, v132, s78
v_and_or_b32 v147, v147, v132, s79
global_store_dwordx4 v129, v[144:147], s[26:27] sc1
s_waitcnt vmcnt(0)
L_gp_poll:
global_load_dwordx4 v[144:147], v128, s[26:27] offset:0 sc1
global_load_dwordx4 v[148:151], v128, s[26:27] offset:1024 sc1
global_load_dwordx4 v[152:155], v128, s[26:27] offset:2048 sc1
s_sub_u32 s60, s60, 1
s_cmp_eq_u32 s60, 0
s_waitcnt vmcnt(0)
s_cbranch_scc1 L_gp_ok
v_xor_b32 v144, s76, v144
v_xor_b32 v145, s77, v145
v_xor_b32 v146, s78, v146
v_xor_b32 v147, s79, v147
v_xor_b32 v148, s76, v148
v_xor_b32 v149, s77, v149
v_xor_b32 v150, s78, v150
v_xor_b32 v151, s79, v151
v_xor_b32 v152, s76, v152
v_xor_b32 v153, s77, v153
v_xor_b32 v154, s78, v154
v_xor_b32 v155, s79, v155
v_or_b32 v76, v144, v145
v_or3_b32 v76, v76, v146, v147
v_or3_b32 v76, v76, v148, v149
v_or3_b32 v76, v76, v150, v151
v_or3_b32 v76, v76, v152, v153
v_or3_b32 v76, v76, v154, v155
v_and_b32 v76, 0xff, v76
v_cmp_ne_u32 vcc, 0, v76
s_cbranch_vccnz L_gp_poll
L_gp_ok:
v_pk_add_f32 v[144:145], v[144:145], v[148:149]
v_pk_add_f32 v[146:147], v[146:147], v[150:151]
v_pk_add_f32 v[144:145], v[144:145], v[152:153]
v_pk_add_f32 v[146:147], v[146:147], v[154:155]
v_cvt_pk_bf16_f32 v76, v144, v145
v_cvt_pk_bf16_f32 v77, v146, v147
v_lshlrev_b32 v144, 16, v76
v_and_b32 v145, s56, v76
v_lshlrev_b32 v146, 16, v77
v_and_b32 v147, s56, v77
s_nop 0
v_mov_b32_dpp v148, v144 row_ror:8 row_mask:0xf bank_mask:0xf
v_mov_b32_dpp v149, v145 row_ror:8 row_mask:0xf bank_mask:0xf
v_mov_b32_dpp v150, v146 row_ror:8 row_mask:0xf bank_mask:0xf
v_mov_b32_dpp v151, v147 row_ror:8 row_mask:0xf bank_mask:0xf
v_max_f32 v144, 0, v144
v_max_f32 v145, 0, v145
v_max_f32 v146, 0, v146
v_max_f32 v147, 0, v147
v_pk_mul_f32 v[144:145], v[144:145], v[148:149]
v_pk_mul_f32 v[146:147], v[146:147], v[150:151]
v_cvt_pk_bf16_f32 v144, v144, v145
v_cvt_pk_bf16_f32 v145, v146, v147
s_mov_b32 exec_lo, 0x00ff00ff
s_mov_b32 exec_hi, 0x00ff00ff
ds_write_b64 v127, v[144:145]
s_mov_b64 exec, -1
s_branch L_filled
L_aux:
v_lshrrev_b32 v48, 3, v0
v_and_b32 v49, 6, v48
v_and_b32 v3, 7, v0
v_xor_b32 v3, v3, v49
v_lshlrev_b32 v3, 4, v3
v_lshl_or_b32 v5, v48, 13, v3
v_lshrrev_b32 v49, 5, v0
v_and_b32 v4, 31, v0
v_lshlrev_b32 v4, 2, v4
s_movk_i32 s62, 1152
v_mad_u32_u24 v4, v49, s62, v4
v_mov_b64 v[40:41], -1
v_mov_b64 v[42:43], -1
s_lshl1_add_u32 s52, s28, s30
s_lshl_b32 s51, s31, 5
s_add_u32 s52, s52, s51
s_lshl_b32 s51, s52, 8
s_add_u32 s51, s51, 0x20000
v_and_b32 v48, 1, v1
v_lshlrev_b32 v49, 12, v48
v_lshl_or_b32 v49, v2, 4, v49
v_add_u32 v7, s51, v49
s_lshl1_add_u32 s52, s28, s30
s_lshl4_add_u32 s52, s31, s52
s_lshl_b32 s51, s52, 7
s_add_u32 s51, s51, 0x48000
s_mov_b32 exec_lo, 0
v_lshl_add_u32 v7, v48, 4, s51
s_mov_b32 exec_lo, -1
s_mul_i32 s51, s29, 256
s_add_u32 s51, s51, 0xf0000
v_writelane_b32 v7, s51, 33
s_add_u32 s51, s51, 128
v_writelane_b32 v7, s51, 34
s_cmp_lt_u32 s28, 1
s_cselect_b32 s63, 6, 0
s_or_b32 s63, s63, 0x00010001
s_and_b32 s34, s32, 3
s_lshr_b32 s35, s32, 2
s_mul_i32 s51, s35, 1179648
s_lshl2_add_u32 s52, s31, s34
s_lshl_b32 s52, s52, 7
s_add_u32 s51, s51, s52
s_sub_u32 s38, 1179648, s52
s_mov_b32 s39, 0x20000
s_mov_b32 m0, 0x20000
v_mov_b32 v18, 0x25300
v_mov_b32 v19, 0
ds_write_b32 v18, v19
s_waitcnt lgkmcnt(0)
global_load_dword v8, v4, s[4:5] offset:0
global_load_dword v9, v4, s[4:5] offset:128
global_load_dword v10, v4, s[4:5] offset:256
global_load_dword v11, v4, s[4:5] offset:384
global_load_dword v12, v4, s[4:5] offset:512
global_load_dword v13, v4, s[4:5] offset:640
global_load_dword v14, v4, s[4:5] offset:768
global_load_dword v15, v4, s[4:5] offset:896
global_load_dword v16, v4, s[4:5] offset:1024
s_add_u32 s36, s10, s51
s_addc_u32 s37, s11, 0
s_load_dword s70, s[26:27], 0x44000
s_mov_b32 s53, 0
buffer_load_dwordx4 v5, s[36:39], s53 offen offset:0 nt lds
s_mov_b32 s53, 64512
buffer_load_dwordx4 v5, s[36:39], s53 offen offset:1024 nt lds
s_mov_b32 s53, 129024
buffer_load_dwordx4 v5, s[36:39], s53 offen offset:2048 nt lds
s_mov_b32 s53, 193536
buffer_load_dwordx4 v5, s[36:39], s53 offen offset:3072 nt lds
s_add_u32 m0, m0, 4096
s_mov_b32 s53, 262144
buffer_load_dwordx4 v5, s[36:39], s53 offen offset:0 nt lds
s_mov_b32 s53, 326656
buffer_load_dwordx4 v5, s[36:39], s53 offen offset:1024 nt lds
s_mov_b32 s53, 391168
buffer_load_dwordx4 v5, s[36:39], s53 offen offset:2048 nt lds
s_mov_b32 s53, 455680
buffer_load_dwordx4 v5, s[36:39], s53 offen offset:3072 nt lds
s_add_u32 m0, m0, 4096
s_mov_b32 s53, 524288
buffer_load_dwordx4 v5, s[36:39], s53 offen offset:0 nt lds
s_mov_b32 s53, 588800
buffer_load_dwordx4 v5, s[36:39], s53 offen offset:1024 nt lds
s_mov_b32 s53, 653312
buffer_load_dwordx4 v5, s[36:39], s53 offen offset:2048 nt lds
s_mov_b32 s53, 717824
buffer_load_dwordx4 v5, s[36:39], s53 offen offset:3072 nt lds
s_add_u32 m0, m0, 4096
s_mov_b32 s53, 786432
buffer_load_dwordx4 v5, s[36:39], s53 offen offset:0 nt lds
s_mov_b32 s53, 850944
buffer_load_dwordx4 v5, s[36:39], s53 offen offset:1024 nt lds
s_mov_b32 s53, 915456
buffer_load_dwordx4 v5, s[36:39], s53 offen offset:2048 nt lds
s_mov_b32 s53, 979968
buffer_load_dwordx4 v5, s[36:39], s53 offen offset:3072 nt lds
s_add_u32 m0, m0, 4096
s_mov_b32 s53, 1048576
buffer_load_dwordx4 v5, s[36:39], s53 offen offset:0 nt lds
s_mov_b32 s53, 1113088
buffer_load_dwordx4 v5, s[36:39], s53 offen offset:1024 nt lds
s_mov_b32 exec_hi, s63
global_store_dwordx4 v7, v[40:43], s[26:27] sc1
s_mov_b32 exec_hi, -1
s_barrier
s_lshl2_add_u32 s51, s31, s35
s_lshl3_add_u32 s51, s51, s34
s_lshl_b32 s51, s51, 8
v_bfe_u32 v48, v0, 2, 1
v_lshlrev_b32 v48, 10, v48
v_lshl_or_b32 v48, v1, 6, v48
v_and_b32 v49, 3, v0
v_lshl_or_b32 v48, v49, 4, v48
v_add_u32 v6, s51, v48
s_mov_b32 s56, 0xffff0000
v_lshrrev_b32 v48, 2, v0
v_bfe_u32 v49, v0, 3, 2
v_lshlrev_b32 v49, 5, v49
v_lshl_or_b32 v49, v48, 7, v49
v_and_b32 v48, 3, v0
v_lshl_or_b32 v49, v48, 3, v49
v_add_u32 v44, 0x20000, v49
v_xor_b32 v45, 32, v44
v_xor_b32 v46, 64, v44
v_xor_b32 v47, 96, v44
v_mov_b32 v140, 0xffffff00
s_waitcnt lgkmcnt(0)
s_and_b32 s51, s70, 0x80808080
s_and_b32 s70, s70, 0x7f7f7f7f
s_add_u32 s70, s70, 0x04030201
s_xor_b32 s70, s70, s51
s_bfe_u32 s76, s70, 0x80000
s_bfe_u32 s77, s70, 0x80008
s_bfe_u32 s78, s70, 0x80010
s_bfe_u32 s79, s70, 0x80018
s_waitcnt vmcnt(19)
v_lshlrev_b32 v20, 16, v8
v_and_b32 v21, s56, v8
v_lshlrev_b32 v22, 16, v9
v_and_b32 v23, s56, v9
v_lshlrev_b32 v24, 16, v10
v_and_b32 v25, s56, v10
v_lshlrev_b32 v26, 16, v11
v_and_b32 v27, s56, v11
v_lshlrev_b32 v28, 16, v12
v_and_b32 v29, s56, v12
v_lshlrev_b32 v30, 16, v13
v_and_b32 v31, s56, v13
v_lshlrev_b32 v32, 16, v14
v_and_b32 v33, s56, v14
v_lshlrev_b32 v34, 16, v15
v_and_b32 v35, s56, v15
v_lshlrev_b32 v36, 16, v16
v_and_b32 v37, s56, v16
s_mov_b32 s51, 0x3ae38e39
v_pk_add_f32 v[48:49], v[20:21], v[22:23]
v_pk_add_f32 v[48:49], v[48:49], v[24:25]
v_pk_add_f32 v[48:49], v[48:49], v[26:27]
v_pk_add_f32 v[48:49], v[48:49], v[28:29]
v_pk_add_f32 v[48:49], v[48:49], v[30:31]
v_pk_add_f32 v[48:49], v[48:49], v[32:33]
v_pk_add_f32 v[48:49], v[48:49], v[34:35]
v_pk_add_f32 v[48:49], v[48:49], v[36:37]
v_add_f32 v48, v48, v49
s_nop 1
v_add_f32_dpp v48, v48, v48 row_ror:8 row_mask:0xf bank_mask:0xf
s_nop 1
v_add_f32_dpp v48, v48, v48 row_ror:4 row_mask:0xf bank_mask:0xf
s_nop 1
v_add_f32_dpp v48, v48, v48 row_ror:2 row_mask:0xf bank_mask:0xf
s_nop 1
v_add_f32_dpp v48, v48, v48 row_ror:1 row_mask:0xf bank_mask:0xf
v_mov_b32 v49, v48
s_nop 1
v_permlane16_swap_b32 v48, v49
v_add_f32 v48, v48, v49
v_mul_f32 v50, s51, v48
v_pk_add_f32 v[56:57], v[20:21], v[50:51] op_sel_hi:[1,0] neg_lo:[0,1] neg_hi:[0,1]
v_pk_add_f32 v[58:59], v[22:23], v[50:51] op_sel_hi:[1,0] neg_lo:[0,1] neg_hi:[0,1]
v_pk_add_f32 v[60:61], v[24:25], v[50:51] op_sel_hi:[1,0] neg_lo:[0,1] neg_hi:[0,1]
v_pk_add_f32 v[62:63], v[26:27], v[50:51] op_sel_hi:[1,0] neg_lo:[0,1] neg_hi:[0,1]
v_pk_add_f32 v[64:65], v[28:29], v[50:51] op_sel_hi:[1,0] neg_lo:[0,1] neg_hi:[0,1]
v_pk_add_f32 v[66:67], v[30:31], v[50:51] op_sel_hi:[1,0] neg_lo:[0,1] neg_hi:[0,1]
v_pk_add_f32 v[68:69], v[32:33], v[50:51] op_sel_hi:[1,0] neg_lo:[0,1] neg_hi:[0,1]
v_pk_add_f32 v[70:71], v[34:35], v[50:51] op_sel_hi:[1,0] neg_lo:[0,1] neg_hi:[0,1]
v_pk_add_f32 v[72:73], v[36:37], v[50:51] op_sel_hi:[1,0] neg_lo:[0,1] neg_hi:[0,1]
v_pk_mul_f32 v[48:49], v[56:57], v[56:57]
v_pk_fma_f32 v[48:49], v[58:59], v[58:59], v[48:49]
v_pk_fma_f32 v[48:49], v[60:61], v[60:61], v[48:49]
v_pk_fma_f32 v[48:49], v[62:63], v[62:63], v[48:49]
v_pk_fma_f32 v[48:49], v[64:65], v[64:65], v[48:49]
v_pk_fma_f32 v[48:49], v[66:67], v[66:67], v[48:49]
v_pk_fma_f32 v[48:49], v[68:69], v[68:69], v[48:49]
v_pk_fma_f32 v[48:49], v[70:71], v[70:71], v[48:49]
v_pk_fma_f32 v[48:49], v[72:73], v[72:73], v[48:49]
v_add_f32 v48, v48, v49
s_nop 1
v_add_f32_dpp v48, v48, v48 row_ror:8 row_mask:0xf bank_mask:0xf
s_nop 1
v_add_f32_dpp v48, v48, v48 row_ror:4 row_mask:0xf bank_mask:0xf
s_nop 1
v_add_f32_dpp v48, v48, v48 row_ror:2 row_mask:0xf bank_mask:0xf
s_nop 1
v_add_f32_dpp v48, v48, v48 row_ror:1 row_mask:0xf bank_mask:0xf
v_mov_b32 v49, v48
s_nop 1
v_permlane16_swap_b32 v48, v49
v_add_f32 v48, v48, v49
v_mul_f32 v48, s51, v48
v_cvt_pk_bf16_f32 v48, v48, v50
v_and_b32 v50, s56, v48
v_lshlrev_b32 v48, 16, v48
v_add_f32 v48, 0x3727c5ac, v48
v_cvt_pk_bf16_f32 v48, v48, v48
v_lshlrev_b32 v48, 16, v48
v_sqrt_f32 v48, v48
v_pk_add_f32 v[20:21], v[20:21], v[50:51] op_sel_hi:[1,0] neg_lo:[0,1] neg_hi:[0,1]
v_pk_add_f32 v[22:23], v[22:23], v[50:51] op_sel_hi:[1,0] neg_lo:[0,1] neg_hi:[0,1]
v_pk_add_f32 v[24:25], v[24:25], v[50:51] op_sel_hi:[1,0] neg_lo:[0,1] neg_hi:[0,1]
v_pk_add_f32 v[26:27], v[26:27], v[50:51] op_sel_hi:[1,0] neg_lo:[0,1] neg_hi:[0,1]
v_pk_add_f32 v[28:29], v[28:29], v[50:51] op_sel_hi:[1,0] neg_lo:[0,1] neg_hi:[0,1]
v_pk_add_f32 v[30:31], v[30:31], v[50:51] op_sel_hi:[1,0] neg_lo:[0,1] neg_hi:[0,1]
v_pk_add_f32 v[32:33], v[32:33], v[50:51] op_sel_hi:[1,0] neg_lo:[0,1] neg_hi:[0,1]
v_pk_add_f32 v[34:35], v[34:35], v[50:51] op_sel_hi:[1,0] neg_lo:[0,1] neg_hi:[0,1]
v_pk_add_f32 v[36:37], v[36:37], v[50:51] op_sel_hi:[1,0] neg_lo:[0,1] neg_hi:[0,1]
v_cvt_pk_bf16_f32 v48, v48, v48
v_lshlrev_b32 v48, 16, v48
v_rcp_f32 v52, v48
v_cvt_pk_bf16_f32 v8, v20, v21
v_cvt_pk_bf16_f32 v9, v22, v23
v_cvt_pk_bf16_f32 v10, v24, v25
v_cvt_pk_bf16_f32 v11, v26, v27
v_cvt_pk_bf16_f32 v12, v28, v29
v_cvt_pk_bf16_f32 v13, v30, v31
v_cvt_pk_bf16_f32 v14, v32, v33
v_cvt_pk_bf16_f32 v15, v34, v35
v_cvt_pk_bf16_f32 v16, v36, v37
v_lshlrev_b32 v20, 16, v8
v_and_b32 v21, s56, v8
v_lshlrev_b32 v22, 16, v9
v_and_b32 v23, s56, v9
v_lshlrev_b32 v24, 16, v10
v_and_b32 v25, s56, v10
v_lshlrev_b32 v26, 16, v11
v_and_b32 v27, s56, v11
v_lshlrev_b32 v28, 16, v12
v_and_b32 v29, s56, v12
v_lshlrev_b32 v30, 16, v13
v_and_b32 v31, s56, v13
v_lshlrev_b32 v32, 16, v14
v_and_b32 v33, s56, v14
v_lshlrev_b32 v34, 16, v15
v_and_b32 v35, s56, v15
v_lshlrev_b32 v36, 16, v16
v_and_b32 v37, s56, v16
v_pk_mul_f32 v[56:57], v[20:21], v[52:53] op_sel_hi:[1,0]
v_pk_mul_f32 v[58:59], v[22:23], v[52:53] op_sel_hi:[1,0]
v_pk_mul_f32 v[60:61], v[24:25], v[52:53] op_sel_hi:[1,0]
v_pk_mul_f32 v[62:63], v[26:27], v[52:53] op_sel_hi:[1,0]
v_pk_mul_f32 v[64:65], v[28:29], v[52:53] op_sel_hi:[1,0]
v_pk_mul_f32 v[66:67], v[30:31], v[52:53] op_sel_hi:[1,0]
v_pk_mul_f32 v[68:69], v[32:33], v[52:53] op_sel_hi:[1,0]
v_pk_mul_f32 v[70:71], v[34:35], v[52:53] op_sel_hi:[1,0]
v_pk_mul_f32 v[72:73], v[36:37], v[52:53] op_sel_hi:[1,0]
v_pk_fma_f32 v[20:21], v[56:57], v[48:49], v[20:21] op_sel_hi:[1,0,1] neg_lo:[1,0,0] neg_hi:[1,0,0]
v_pk_fma_f32 v[22:23], v[58:59], v[48:49], v[22:23] op_sel_hi:[1,0,1] neg_lo:[1,0,0] neg_hi:[1,0,0]
v_pk_fma_f32 v[24:25], v[60:61], v[48:49], v[24:25] op_sel_hi:[1,0,1] neg_lo:[1,0,0] neg_hi:[1,0,0]
v_pk_fma_f32 v[26:27], v[62:63], v[48:49], v[26:27] op_sel_hi:[1,0,1] neg_lo:[1,0,0] neg_hi:[1,0,0]
v_pk_fma_f32 v[28:29], v[64:65], v[48:49], v[28:29] op_sel_hi:[1,0,1] neg_lo:[1,0,0] neg_hi:[1,0,0]
v_pk_fma_f32 v[30:31], v[66:67], v[48:49], v[30:31] op_sel_hi:[1,0,1] neg_lo:[1,0,0] neg_hi:[1,0,0]
v_pk_fma_f32 v[32:33], v[68:69], v[48:49], v[32:33] op_sel_hi:[1,0,1] neg_lo:[1,0,0] neg_hi:[1,0,0]
v_pk_fma_f32 v[34:35], v[70:71], v[48:49], v[34:35] op_sel_hi:[1,0,1] neg_lo:[1,0,0] neg_hi:[1,0,0]
v_pk_fma_f32 v[36:37], v[72:73], v[48:49], v[36:37] op_sel_hi:[1,0,1] neg_lo:[1,0,0] neg_hi:[1,0,0]
v_pk_fma_f32 v[56:57], v[20:21], v[52:53], v[56:57] op_sel_hi:[1,0,1]
v_pk_fma_f32 v[58:59], v[22:23], v[52:53], v[58:59] op_sel_hi:[1,0,1]
v_pk_fma_f32 v[60:61], v[24:25], v[52:53], v[60:61] op_sel_hi:[1,0,1]
v_pk_fma_f32 v[62:63], v[26:27], v[52:53], v[62:63] op_sel_hi:[1,0,1]
v_pk_fma_f32 v[64:65], v[28:29], v[52:53], v[64:65] op_sel_hi:[1,0,1]
v_pk_fma_f32 v[66:67], v[30:31], v[52:53], v[66:67] op_sel_hi:[1,0,1]
v_pk_fma_f32 v[68:69], v[32:33], v[52:53], v[68:69] op_sel_hi:[1,0,1]
v_pk_fma_f32 v[70:71], v[34:35], v[52:53], v[70:71] op_sel_hi:[1,0,1]
v_pk_fma_f32 v[72:73], v[36:37], v[52:53], v[72:73] op_sel_hi:[1,0,1]
v_add_u32 v48, 0x24800, v4
v_cvt_pk_bf16_f32 v8, v56, v57
ds_write_b32 v48, v8 offset:0
v_cvt_pk_bf16_f32 v9, v58, v59
ds_write_b32 v48, v9 offset:128
v_cvt_pk_bf16_f32 v10, v60, v61
ds_write_b32 v48, v10 offset:256
v_cvt_pk_bf16_f32 v11, v62, v63
ds_write_b32 v48, v11 offset:384
v_cvt_pk_bf16_f32 v12, v64, v65
ds_write_b32 v48, v12 offset:512
v_cvt_pk_bf16_f32 v13, v66, v67
ds_write_b32 v48, v13 offset:640
v_cvt_pk_bf16_f32 v14, v68, v69
ds_write_b32 v48, v14 offset:768
v_cvt_pk_bf16_f32 v15, v70, v71
ds_write_b32 v48, v15 offset:896
v_cvt_pk_bf16_f32 v16, v72, v73
ds_write_b32 v48, v16 offset:1024
v_mov_b32 v19, 1
ds_write_b32 v18, v19
s_mul_i32 s51, s35, 288
s_add_u32 s51, s51, 0x24800
v_bfe_u32 v48, v0, 2, 1
v_mul_u32_u24 v48, 1152, v48
v_lshl_add_u32 v48, v1, 3, v48
v_add_u32 v48, s51, v48
ds_read_b64 v[56:57], v48 offset:0
ds_read_b64 v[58:59], v48 offset:32
ds_read_b64 v[60:61], v48 offset:64
ds_read_b64 v[62:63], v48 offset:96
ds_read_b64 v[64:65], v48 offset:128
s_waitcnt lgkmcnt(14)
ds_read_b64 v[66:67], v48 offset:160
s_waitcnt lgkmcnt(14)
ds_read_b64 v[68:69], v48 offset:192
s_waitcnt lgkmcnt(14)
ds_read_b64 v[70:71], v48 offset:224
s_waitcnt lgkmcnt(14)
ds_read_b64 v[72:73], v48 offset:256
s_waitcnt vmcnt(1) lgkmcnt(0)
ds_read_b64_tr_b16 v[76:77], v44 offset:0
ds_read_b64_tr_b16 v[78:79], v44 offset:2048
ds_read_b64_tr_b16 v[80:81], v45 offset:0
ds_read_b64_tr_b16 v[82:83], v45 offset:2048
ds_read_b64_tr_b16 v[84:85], v46 offset:0
ds_read_b64_tr_b16 v[86:87], v46 offset:2048
ds_read_b64_tr_b16 v[88:89], v47 offset:0
ds_read_b64_tr_b16 v[90:91], v47 offset:2048
ds_read_b64_tr_b16 v[92:93], v44 offset:4096
ds_read_b64_tr_b16 v[94:95], v44 offset:6144
ds_read_b64_tr_b16 v[96:97], v45 offset:4096
ds_read_b64_tr_b16 v[98:99], v45 offset:6144
ds_read_b64_tr_b16 v[100:101], v46 offset:4096
ds_read_b64_tr_b16 v[102:103], v46 offset:6144
ds_read_b64_tr_b16 v[104:105], v47 offset:4096
s_waitcnt lgkmcnt(14)
ds_read_b64_tr_b16 v[106:107], v47 offset:6144
s_waitcnt lgkmcnt(8)
v_mfma_f32_16x16x32_bf16 v[108:111], v[76:79], v[56:59], 0
v_mfma_f32_16x16x32_bf16 v[112:115], v[80:83], v[56:59], 0
v_mfma_f32_16x16x32_bf16 v[116:119], v[84:87], v[56:59], 0
v_mfma_f32_16x16x32_bf16 v[120:123], v[88:91], v[56:59], 0
ds_read_b64_tr_b16 v[76:77], v44 offset:8192
ds_read_b64_tr_b16 v[78:79], v44 offset:10240
ds_read_b64_tr_b16 v[80:81], v45 offset:8192
ds_read_b64_tr_b16 v[82:83], v45 offset:10240
ds_read_b64_tr_b16 v[84:85], v46 offset:8192
ds_read_b64_tr_b16 v[86:87], v46 offset:10240
ds_read_b64_tr_b16 v[88:89], v47 offset:8192
s_waitcnt lgkmcnt(14)
ds_read_b64_tr_b16 v[90:91], v47 offset:10240
s_waitcnt lgkmcnt(8)
v_mfma_f32_16x16x32_bf16 v[108:111], v[92:95], v[60:63], v[108:111]
v_mfma_f32_16x16x32_bf16 v[112:115], v[96:99], v[60:63], v[112:115]
v_mfma_f32_16x16x32_bf16 v[116:119], v[100:103], v[60:63], v[116:119]
v_mfma_f32_16x16x32_bf16 v[120:123], v[104:107], v[60:63], v[120:123]
ds_read_b64_tr_b16 v[92:93], v44 offset:12288
ds_read_b64_tr_b16 v[94:95], v44 offset:14336
ds_read_b64_tr_b16 v[96:97], v45 offset:12288
ds_read_b64_tr_b16 v[98:99], v45 offset:14336
ds_read_b64_tr_b16 v[100:101], v46 offset:12288
ds_read_b64_tr_b16 v[102:103], v46 offset:14336
ds_read_b64_tr_b16 v[104:105], v47 offset:12288
s_waitcnt lgkmcnt(14)
ds_read_b64_tr_b16 v[106:107], v47 offset:14336
s_waitcnt lgkmcnt(8)
v_mfma_f32_16x16x32_bf16 v[108:111], v[76:79], v[64:67], v[108:111]
v_mfma_f32_16x16x32_bf16 v[112:115], v[80:83], v[64:67], v[112:115]
v_mfma_f32_16x16x32_bf16 v[116:119], v[84:87], v[64:67], v[116:119]
v_mfma_f32_16x16x32_bf16 v[120:123], v[88:91], v[64:67], v[120:123]
ds_read_b64_tr_b16 v[76:77], v44 offset:16384
ds_read_b64_tr_b16 v[80:81], v45 offset:16384
ds_read_b64_tr_b16 v[84:85], v46 offset:16384
ds_read_b64_tr_b16 v[88:89], v47 offset:16384
s_waitcnt lgkmcnt(4)
v_mfma_f32_16x16x32_bf16 v[108:111], v[92:95], v[68:71], v[108:111]
v_mfma_f32_16x16x32_bf16 v[112:115], v[96:99], v[68:71], v[112:115]
v_mfma_f32_16x16x32_bf16 v[116:119], v[100:103], v[68:71], v[116:119]
v_mfma_f32_16x16x32_bf16 v[120:123], v[104:107], v[68:71], v[120:123]
s_waitcnt lgkmcnt(0)
v_mfma_f32_16x16x16_bf16 v[108:111], v[76:77], v[72:73], v[108:111]
v_mfma_f32_16x16x16_bf16 v[112:115], v[80:81], v[72:73], v[112:115]
v_mfma_f32_16x16x16_bf16 v[116:119], v[84:85], v[72:73], v[116:119]
v_mfma_f32_16x16x16_bf16 v[120:123], v[88:89], v[72:73], v[120:123]
s_mov_b32 s64, 0x22222222
s_mov_b32 s65, 0x22222222
s_mov_b32 s66, 0x44444444
s_mov_b32 s67, 0x44444444
s_mov_b32 s68, 0x88888888
s_mov_b32 s69, 0x88888888
s_mov_b32 s60, 20000
s_lshl3_add_u32 s51, s31, s30
s_lshl_b32 s51, s51, 10
v_lshl_add_u32 v52, v0, 4, s51
v_add_u32 v53, 0x1000, v52
v_cndmask_b32 v108, v108, v112, s[64:65]
v_cndmask_b32 v109, v109, v113, s[64:65]
v_cndmask_b32 v110, v110, v114, s[64:65]
v_cndmask_b32 v111, v111, v115, s[64:65]
v_cndmask_b32 v108, v108, v116, s[66:67]
v_cndmask_b32 v109, v109, v117, s[66:67]
v_cndmask_b32 v110, v110, v118, s[66:67]
v_cndmask_b32 v111, v111, v119, s[66:67]
v_cndmask_b32 v108, v108, v120, s[68:69]
v_cndmask_b32 v109, v109, v121, s[68:69]
v_cndmask_b32 v110, v110, v122, s[68:69]
v_cndmask_b32 v111, v111, v123, s[68:69]
v_and_or_b32 v108, v108, v140, s76
v_and_or_b32 v109, v109, v140, s77
v_and_or_b32 v110, v110, v140, s78
v_and_or_b32 v111, v111, v140, s79
s_waitcnt vmcnt(0)
s_mov_b32 exec_lo, 0x00ff00ff
s_mov_b32 exec_hi, 0x00ff00ff
global_store_dwordx4 v6, v[108:111], s[26:27] sc1
s_mov_b64 exec, -1
v_mov_b32 v19, 2
ds_write_b32 v18, v19
s_mov_b32 s60, 20000
L_q_poll:
global_load_dwordx4 v[144:147], v52, s[26:27] offset:0 sc1
global_load_dwordx4 v[148:151], v52, s[26:27] offset:2048 sc1
global_load_dwordx4 v[152:155], v53, s[26:27] offset:0 sc1
global_load_dwordx4 v[156:159], v53, s[26:27] offset:2048 sc1
s_sub_u32 s60, s60, 1
s_cmp_eq_u32 s60, 0
s_waitcnt vmcnt(0)
s_cbranch_scc1 L_q_ok
v_xor_b32 v144, s76, v144
v_xor_b32 v145, s77, v145
v_xor_b32 v146, s78, v146
v_xor_b32 v147, s79, v147
v_xor_b32 v148, s76, v148
v_xor_b32 v149, s77, v149
v_xor_b32 v150, s78, v150
v_xor_b32 v151, s79, v151
v_xor_b32 v152, s76, v152
v_xor_b32 v153, s77, v153
v_xor_b32 v154, s78, v154
v_xor_b32 v155, s79, v155
v_xor_b32 v156, s76, v156
v_xor_b32 v157, s77, v157
v_xor_b32 v158, s78, v158
v_xor_b32 v159, s79, v159
v_or_b32 v48, v144, v145
v_or3_b32 v48, v48, v146, v147
v_or3_b32 v48, v48, v148, v149
v_or3_b32 v48, v48, v150, v151
v_or3_b32 v48, v48, v152, v153
v_or3_b32 v48, v48, v154, v155
v_or3_b32 v48, v48, v156, v157
v_or3_b32 v48, v48, v158, v159
v_and_b32 v48, 0xff, v48
v_cmp_ne_u32 vcc, 0, v48
s_cbranch_vccnz L_q_poll
L_q_ok:
v_pk_add_f32 v[144:145], v[144:145], v[148:149]
v_pk_add_f32 v[152:153], v[152:153], v[156:157]
v_pk_add_f32 v[146:147], v[146:147], v[150:151]
v_pk_add_f32 v[154:155], v[154:155], v[158:159]
v_pk_add_f32 v[144:145], v[144:145], v[152:153]
v_pk_add_f32 v[146:147], v[146:147], v[154:155]
v_and_b32 v48, 3, v0
v_lshlrev_b32 v48, 5, v48
v_lshl_or_b32 v48, v1, 7, v48
v_bfe_u32 v49, v0, 2, 2
v_lshl_or_b32 v48, v49, 3, v48
v_add_u32 v48, 0x25100, v48
v_cvt_pk_bf16_f32 v144, v144, v145
v_cvt_pk_bf16_f32 v145, v146, v147
ds_write_b64 v48, v[144:145]
v_mov_b32 v19, 3
ds_write_b32 v18, v19
s_cmp_ge_u32 s61, 72
s_cbranch_scc1 L_combine
v_lshrrev_b32 v48, 2, v0
v_mul_u32_u24 v48, 4608, v48
v_and_b32 v49, 3, v0
v_lshl_or_b32 v48, v49, 4, v48
s_lshl_b32 s51, s61, 6
s_add_u32 s52, s51, 0x50000
v_add_u32 v13, s52, v48
v_add_u32 v14, 73728, v13
s_add_u32 s52, s51, 0x80000
v_add_u32 v20, s52, v48
v_add_u32 v21, 73728, v20
v_add_u32 v22, 73728, v21
v_add_u32 v23, 73728, v22
v_add_u32 v24, 73728, v23
s_lshr_b32 s51, s61, 2
s_lshl_b32 s51, s51, 6
s_and_b32 s52, s61, 3
s_lshl3_add_u32 s51, s52, s51
v_and_b32 v48, 1, v0
v_mul_u32_u24 v48, 1152, v48
v_bfe_u32 v49, v0, 1, 1
v_lshl_add_u32 v48, v49, 5, v48
v_bfe_u32 v49, v0, 4, 1
v_lshl_add_u32 v48, v49, 2, v48
v_lshrrev_b32 v49, 5, v0
v_lshl_add_u32 v48, v49, 1, v48
v_add_u32 v12, s51, v48
global_load_ushort v10, v12, s[4:5]
L_combine:
v_and_b32 v26, 1, v1
v_lshlrev_b32 v27, 3, v26
v_lshlrev_b32 v26, 9, v26
v_lshl_or_b32 v26, v2, 5, v26
v_lshrrev_b32 v48, 5, v0
v_lshl_or_b32 v26, v48, 4, v26
s_mov_b32 s58, -1
s_mov_b32 s59, 20000
s_barrier
L_cb:
ds_read_b64 v[56:57], v27 offset:1024
ds_read_b64 v[58:59], v27 offset:17408
ds_read_b64 v[60:61], v27 offset:33792
ds_read_b128 v[76:79], v26 offset:0
ds_read_b128 v[80:83], v26 offset:16384
ds_read_b128 v[84:87], v26 offset:32768
s_waitcnt lgkmcnt(3)
v_max3_f32 v110, v56, v58, v60
v_sub_f32 v56, v56, v110
v_sub_f32 v58, v58, v110
v_sub_f32 v60, v60, v110
v_exp_f32 v56, v56
v_exp_f32 v58, v58
v_exp_f32 v60, v60
v_mul_f32 v111, v56, v57
v_fmac_f32 v111, v58, v59
v_fmac_f32 v111, v60, v61
s_waitcnt lgkmcnt(0)
v_pk_mul_f32 v[76:77], v[76:77], v[56:57] op_sel_hi:[1,0]
v_pk_mul_f32 v[78:79], v[78:79], v[56:57] op_sel_hi:[1,0]
v_pk_fma_f32 v[76:77], v[80:81], v[58:59], v[76:77] op_sel_hi:[1,0,1]
v_pk_fma_f32 v[78:79], v[82:83], v[58:59], v[78:79] op_sel_hi:[1,0,1]
v_pk_fma_f32 v[76:77], v[84:85], v[60:61], v[76:77] op_sel_hi:[1,0,1]
v_pk_fma_f32 v[78:79], v[86:87], v[60:61], v[78:79] op_sel_hi:[1,0,1]
v_cvt_pk_bf16_f32 v108, v76, v77
v_cvt_pk_bf16_f32 v109, v78, v79
v_min_u32 v110, -2, v110
v_min_u32 v111, -2, v111
v_min_u32 v108, -2, v108
v_min_u32 v109, -2, v109
s_nop 1
v_permlane32_swap_b32 v108, v110
v_permlane32_swap_b32 v109, v111
s_mov_b32 exec_lo, s58
s_and_b32 exec_hi, s58, 0x00010001
global_store_dwordx4 v7, v[108:111], s[26:27] sc1
s_mov_b64 exec, -1
s_cmp_ge_u32 s61, 72
s_cbranch_scc1 L_notred
s_mov_b32 s60, s59
v_mov_b32 v132, s76
v_mov_b32 v133, s77
v_mov_b32 v134, s78
v_mov_b32 v135, s79
s_mov_b64 s[48:49], -1
s_mov_b64 vcc, -1
L_dp_poll:
s_mov_b64 exec, vcc
global_load_dwordx4 v[76:79], v13, s[26:27] sc1
global_load_dwordx4 v[80:83], v14, s[26:27] sc1
s_mov_b64 exec, s[48:49]
global_load_dwordx4 v[116:119], v20, s[26:27] sc1
global_load_dwordx4 v[120:123], v21, s[26:27] sc1
global_load_dwordx4 v[124:127], v22, s[26:27] sc1
global_load_dwordx4 v[128:131], v23, s[26:27] sc1
s_mov_b32 exec_hi, 0
global_load_dwordx4 v[132:135], v24, s[26:27] sc1
s_mov_b64 exec, -1
s_sub_u32 s60, s60, 1
s_waitcnt vmcnt(0)
v_xor_b32 v144, s76, v116
v_xor_b32 v145, s77, v117
v_xor_b32 v146, s78, v118
v_xor_b32 v147, s79, v119
v_xor_b32 v148, s76, v120
v_xor_b32 v149, s77, v121
v_xor_b32 v150, s78, v122
v_xor_b32 v151, s79, v123
v_xor_b32 v152, s76, v124
v_xor_b32 v153, s77, v125
v_xor_b32 v154, s78, v126
v_xor_b32 v155, s79, v127
v_xor_b32 v156, s76, v128
v_xor_b32 v157, s77, v129
v_xor_b32 v158, s78, v130
v_xor_b32 v159, s79, v131
v_xor_b32 v160, s76, v132
v_xor_b32 v161, s77, v133
v_xor_b32 v162, s78, v134
v_xor_b32 v163, s79, v135
v_or_b32 v48, v144, v145
v_or3_b32 v48, v48, v146, v147
v_or3_b32 v48, v48, v148, v149
v_or3_b32 v48, v48, v150, v151
v_or3_b32 v48, v48, v152, v153
v_or3_b32 v48, v48, v154, v155
v_or3_b32 v48, v48, v156, v157
v_or3_b32 v48, v48, v158, v159
v_or3_b32 v48, v48, v160, v161
v_or3_b32 v48, v48, v162, v163
v_and_b32 v48, 0xff, v48
v_cmp_ne_u32 vcc, 0, v48
s_cselect_b64 s[48:49], 0, vcc
v_xor_b32 v84, s76, v76
v_xor_b32 v85, s77, v77
v_xor_b32 v86, s78, v78
v_xor_b32 v87, s79, v79
v_xor_b32 v88, s76, v80
v_xor_b32 v89, s77, v81
v_xor_b32 v90, s78, v82
v_xor_b32 v91, s79, v83
v_or_b32 v48, v84, v85
v_or3_b32 v48, v48, v86, v87
v_or3_b32 v48, v48, v88, v89
v_or3_b32 v48, v48, v90, v91
v_and_b32 v48, 0xff, v48
v_cmp_ne_u32 vcc, 0, v48
s_cmp_lg_u64 s[48:49], 0
s_cbranch_scc1 L_dp_poll
s_mov_b64 exec, vcc
global_load_dwordx4 v[76:79], v13, s[26:27] sc1
global_load_dwordx4 v[80:83], v14, s[26:27] sc1
s_mov_b64 exec, -1
v_pk_add_f32 v[144:145], v[144:145], v[148:149]
v_pk_add_f32 v[146:147], v[146:147], v[150:151]
v_pk_add_f32 v[144:145], v[144:145], v[152:153]
v_pk_add_f32 v[146:147], v[146:147], v[154:155]
v_pk_add_f32 v[144:145], v[144:145], v[156:157]
v_pk_add_f32 v[146:147], v[146:147], v[158:159]
v_pk_add_f32 v[144:145], v[144:145], v[160:161]
v_pk_add_f32 v[146:147], v[146:147], v[162:163]
s_nop 1
v_permlane32_swap_b32 v144, v145
v_permlane32_swap_b32 v146, v147
v_add_f32 v144, v144, v145
v_add_f32 v146, v146, v147
s_nop 1
v_permlane16_swap_b32 v144, v146
v_add_f32 v144, v144, v146
s_nop 1
v_add_f32_dpp v144, v144, v144 row_ror:8 row_mask:0xf bank_mask:0xf
s_nop 1
v_add_f32_dpp v144, v144, v144 row_ror:4 row_mask:0xf bank_mask:0xf
v_cvt_pk_bf16_f32 v144, v144, v144
v_lshlrev_b32 v144, 16, v144
v_mul_f32 v48, 0xbfb8aa3b, v144
v_exp_f32 v48, v48
v_lshlrev_b32 v28, 16, v10
v_add_f32 v48, 1.0, v48
v_rcp_f32 v48, v48
s_mov_b32 s60, s59
v_mul_f32 v48, v48, v144
v_cvt_pk_bf16_f32 v48, v48, v48
v_lshlrev_b32 v11, 16, v48
L_sp_poll:
s_waitcnt vmcnt(0)
v_xor_b32 v144, s76, v76
v_xor_b32 v145, s77, v77
v_xor_b32 v146, s78, v78
v_xor_b32 v147, s79, v79
v_xor_b32 v148, s76, v80
v_xor_b32 v149, s77, v81
v_xor_b32 v150, s78, v82
v_xor_b32 v151, s79, v83
v_or_b32 v48, v144, v145
v_or3_b32 v48, v48, v146, v147
v_or3_b32 v48, v48, v148, v149
v_or3_b32 v48, v48, v150, v151
v_and_b32 v48, 0xff, v48
v_cmp_ne_u32 vcc, 0, v48
s_cbranch_vccz L_sp_ok
s_and_b32 exec_lo, vcc_lo, s58
s_and_b32 exec_hi, vcc_hi, s58
global_load_dwordx4 v[76:79], v13, s[26:27] sc1
global_load_dwordx4 v[80:83], v14, s[26:27] sc1
s_mov_b64 exec, -1
s_sub_u32 s60, s60, 1
s_cmp_lg_u32 s60, 0
s_cbranch_scc1 L_sp_poll
L_sp_ok:
v_pk_add_f32 v[144:145], v[144:145], v[148:149]
v_pk_add_f32 v[146:147], v[146:147], v[150:151]
s_nop 1
v_permlane32_swap_b32 v144, v145
v_permlane32_swap_b32 v146, v147
v_add_f32 v144, v144, v145
v_add_f32 v146, v146, v147
s_nop 1
v_permlane16_swap_b32 v144, v146
v_add_f32 v144, v144, v146
s_nop 1
v_add_f32_dpp v144, v144, v144 row_ror:8 row_mask:0xf bank_mask:0xf
s_nop 1
v_add_f32_dpp v144, v144, v144 row_ror:4 row_mask:0xf bank_mask:0xf
v_cvt_pk_bf16_f32 v144, v144, v144
v_lshlrev_b32 v144, 16, v144
v_mul_f32 v144, v144, v11
v_cvt_pk_bf16_f32 v144, v144, v144
v_lshlrev_b32 v144, 16, v144
v_add_f32 v144, v144, v28
v_cvt_pk_bf16_f32 v144, v144, v144
s_and_b32 exec_lo, s58, 0x000f000f
s_and_b32 exec_hi, s58, 0x000f000f
global_store_short v12, v144, s[22:23]
s_cmp_lg_u32 s61, 0
s_cbranch_scc1 L_aux_end
s_mov_b64 exec, 1
v_mov_b32 v48, 0x44000
v_mov_b32 v49, s70
global_store_dword v48, v49, s[26:27] sc1
s_branch L_aux_end
L_notred:
s_barrier
L_aux_end:
L_end:
s_endpgm
.section .rodata,"a"
.p2align 6
.amdhsa_kernel recurrent_scan__gqa_block_cached__glu_gated_reglu__decode_kernel
  .amdhsa_next_free_vgpr 168
  .amdhsa_next_free_sgpr 102
  .amdhsa_accum_offset 168
  .amdhsa_group_segment_fixed_size 0
  .amdhsa_kernarg_size 96
  .amdhsa_user_sgpr_count 2
  .amdhsa_user_sgpr_kernarg_segment_ptr 1
  .amdhsa_system_sgpr_workgroup_id_x 1
.end_amdhsa_kernel
```
